```python
import torch

def _softmax(x, axis=-1):
    return torch.softmax(x, dim=axis)
def _gelu(x):
    return torch.nn.functional.gelu(x, approximate="tanh")
def _silu(x):
    return torch.nn.functional.silu(x)
def _sigmoid(x):
    return torch.sigmoid(x)
def _layernorm(x, axis=-1, eps=1e-5):
    m = x.mean(dim=axis, keepdim=True)
    v = x.var(dim=axis, keepdim=True, unbiased=False)
    return (x - m) / torch.sqrt(v + eps)
def _scatter_add(tgt, idx, src, axis=0):
    return tgt.clone().index_add_(axis, idx, src)
def _segment_sum(src, seg, n):
    out = torch.zeros((n,) + src.shape[1:], dtype=src.dtype)
    return out.index_add_(0, seg, src)
def _pad(x, pw):
    flat = tuple(v for pair in reversed(pw) for v in pair)
    return torch.nn.functional.pad(x, flat)

kernel_name = 'recurrent_scan__ssm_conv_h3__dense_activation_squared_relu__prompt'

def setup_inputs():

    _w = (lambda a: (lambda t: t.to(torch.bfloat16) if t.is_floating_point() else t)(torch.as_tensor(a)))
    def _A_setup():
        B, S, D = 1, 2048, 448
        ks = 4
        return {
            "q": _w((lambda *s: torch.randn(*s, dtype=torch.bfloat16) * 0.05)(B, S, D)),
            "k": _w((lambda *s: torch.randn(*s, dtype=torch.bfloat16) * 0.2)(B, S, D)),
            "v": _w((lambda *s: torch.randn(*s, dtype=torch.bfloat16) * 0.2)(B, S, D)),
            "shift_k": _w((lambda *s: torch.randn(*s, dtype=torch.bfloat16) * 0.2)(D, ks) * 0.5),
            "ssm_k": _w((lambda *s: torch.randn(*s, dtype=torch.bfloat16) * 0.2)(D, S) * (1.0 / S ** 0.5)),
            "ssm_D": _w((lambda *s: torch.randn(*s, dtype=torch.bfloat16) * 0.2)(D)),
        }
    _A_in = _A_setup()

    def _B_setup():
        B, S, D, F = 1, 2048, 448, 1792
        return {
            "x": _w((lambda *s: torch.randn(*s, dtype=torch.bfloat16) * 0.05)(B, S, D)),
            "w1": _w((lambda *s: torch.randn(*s, dtype=torch.bfloat16) * 0.1)(D, F)),
            "b1": _w((lambda *s: torch.randn(*s, dtype=torch.bfloat16) * 0.4)(F)),
            "w2": _w((lambda *s: torch.randn(*s, dtype=torch.bfloat16) * 0.1)(F, D)),
            "b2": _w((lambda *s: torch.randn(*s, dtype=torch.bfloat16) * 12.8)(D)),
        }
    _B_in = _B_setup()

    return {
        "A_q": _A_in["q"],
        "A_k": _A_in["k"],
        "A_v": _A_in["v"],
        "A_shift_k": _A_in["shift_k"],
        "A_ssm_k": _A_in["ssm_k"],
        "A_ssm_D": _A_in["ssm_D"],
        "B_x": _B_in["x"],
        "B_w1": _B_in["w1"],
        "B_b1": _B_in["b1"],
        "B_w2": _B_in["w2"],
        "B_b2": _B_in["b2"],
    }

def reference(A_q, A_k, A_v, A_shift_k, A_ssm_k, A_ssm_D, B_x, B_w1, B_b1, B_w2, B_b2):
    def _A_ref(q, k, v, shift_k, ssm_k, ssm_D):
        B, S, D = q.shape
        ks = shift_k.shape[-1]
        k_pad = _pad(k, ((0, 0), (ks - 1, 0), (0, 0)))
        k_shift = torch.zeros_like(k)
        for t in range(ks):
            k_shift = k_shift + k_pad[:, t:t + S, :] * shift_k[:, ks - 1 - t][None, None, :]
        kv = k_shift * v
        L = 2 * S
        kv_pad = _pad(kv, ((0, 0), (0, S), (0, 0)))
        kf_pad = _pad(ssm_k, ((0, 0), (0, S)))
        kv_f = (lambda x, axes=(-2,-1): torch.fft.rfft2(x.float(), dim=axes))(kv_pad[:, None, :, :], axes=(1, 2))
        kf_f = (lambda x, axes=(-2,-1): torch.fft.rfft2(x.float(), dim=axes))(kf_pad[:, None, :], axes=(1, 2))
        kf_f = (lambda x, *d: x.permute(*d))(kf_f, 1, 2, 0)
        y_f = kv_f * kf_f[None, :, :, :]
        y = (lambda x, s, axes=(-2,-1): torch.fft.irfft2(x, s=s, dim=axes).to(torch.bfloat16))(y_f, (1, L), axes=(1, 2))[:, 0, :S, :]
        y = y + kv * ssm_D[None, None, :]
        return q * y

    def _B_ref(x, w1, b1, w2, b2):
        h = torch.einsum("bsd,df->bsf", x, w1) + b1
        zero = torch.zeros_like(h)
        r = torch.where(h > zero, h, zero)
        h = r * r
        out = torch.einsum("bsf,fd->bsd", h, w2) + b2
        return out

    x = A_q
    xn = _layernorm(x, axis=-1)
    s = _A_ref(xn, A_k, A_v, A_shift_k, A_ssm_k, A_ssm_D)
    g = _silu(_B_ref(xn, B_w1, B_b1, B_w2, B_b2))
    return x + s * g
```

```asm
; @launch grid=(256,1,1) block=(512,1,1) lds=162176
.amdgcn_target "amdgcn-amd-amdhsa--gfx950"
.text
.globl recurrent_scan__ssm_conv_h3__dense_activation_squared_relu__prompt_kernel
.p2align 8
.type recurrent_scan__ssm_conv_h3__dense_activation_squared_relu__prompt_kernel,@function
recurrent_scan__ssm_conv_h3__dense_activation_squared_relu__prompt_kernel:
    s_cmp_ge_u32 s2, 256
    s_cbranch_scc1 L_end
    s_load_dwordx16 s[64:79], s[0:1], 0
    s_load_dwordx8 s[80:87], s[0:1], 64
    s_load_dwordx4 s[88:91], s[0:1], 96
    v_lshlrev_b32 v113, 4, v0
    v_and_b32 v112, 63, v0
    v_lshrrev_b32 v115, 6, v0
    v_lshlrev_b32 v114, 2, v112
    v_readfirstlane_b32 s43, v115
    v_lshrrev_b32 v80, 3, v112
    v_and_b32 v81, 7, v112
    v_lshrrev_b32 v82, 4, v112
    v_and_b32 v83, 15, v112
    v_mul_u32_u24 v84, 896, v80
    v_lshlrev_b32 v133, 4, v112
    v_mov_b32 v100, 0
    s_cmp_lt_u32 s2, 32
    s_cbranch_scc1 L_service
    s_sub_u32 s57, s2, 32
    s_and_b32 s36, s57, 7
    s_lshr_b32 s92, s57, 3
    s_mul_i32 s37, s92, 37
    s_lshr_b32 s37, s37, 8
    s_mul_i32 s93, s37, 7
    s_sub_u32 s38, s92, s93
    s_lshl_b32 s39, s36, 2
    s_add_u32 s39, s39, s37
    s_lshr_b32 s41, s36, 1
    s_lshl_b32 s41, s41, 2
    s_add_u32 s41, s41, s37
    s_and_b32 s42, s36, 1
    s_mul_i32 s42, s42, 7
    s_add_u32 s42, s42, s38
    s_lshr_b32 s55, s43, 2
    s_and_b32 s56, s43, 3
    s_lshl_b32 s92, s37, 1
    s_add_u32 s92, s92, s38
    s_add_u32 s92, s92, s36
    s_mul_i32 s93, s92, 37
    s_lshr_b32 s93, s93, 8
    s_mul_i32 s93, s93, 7
    s_sub_u32 s49, s92, s93
    s_mov_b32 s99, s49
    s_lshl_b32 s60, s56, 12
    s_lshl_b32 s40, s38, 5
    s_add_u32 s40, s40, s39
    s_cmp_eq_u32 s55, 0
    s_cbranch_scc1 L_sync
    s_lshl_b32 s92, s41, 7
    s_lshl_b32 s93, s56, 5
    s_add_u32 s92, s92, s93
    s_mul_i32 s92, s92, 896
    v_add_u32 v10, s92, v84
    v_lshrrev_b32 v11, 1, v80
    v_xor_b32 v11, v11, v81
    v_lshl_add_u32 v127, v11, 4, v10
    v_xor_b32 v11, 4, v11
    v_lshl_add_u32 v128, v11, 4, v10
    v_add_u32 v128, 7168, v128
    s_mul_i32 s92, s56, 57344
    s_lshl_b32 s93, s42, 8
    s_add_u32 s92, s92, s93
    v_mul_u32_u24 v10, 3584, v82
    v_add_u32 v10, s92, v10
    v_lshlrev_b32 v11, 1, v82
    v_xor_b32 v11, v11, v83
    v_lshl_add_u32 v125, v11, 4, v10
    v_xor_b32 v11, 8, v11
    v_lshl_add_u32 v126, v11, 4, v10
    v_add_u32 v126, 28672, v126
    s_waitcnt lgkmcnt(0)
    s_mov_b32 s4, s64
    s_and_b32 s5, s65, 0xffff
    s_mov_b32 s6, 1835008
    s_mov_b32 s7, 0x00020000
    s_mov_b32 s20, s78
    s_and_b32 s21, s79, 0xffff
    s_mov_b32 s22, 1605632
    s_mov_b32 s23, 0x00020000
    s_lshl_b32 s92, s99, 7
    s_mul_i32 s93, s99, 229376
    s_add_u32 m0, s60, 0
    s_nop 0
    buffer_load_dwordx4 v127, s[4:7], s92 offen lds
    s_add_u32 m0, s60, 1024
    s_nop 0
    buffer_load_dwordx4 v128, s[4:7], s92 offen lds
    s_add_u32 s92, s92, 14336
    s_add_u32 m0, s60, 2048
    s_nop 0
    buffer_load_dwordx4 v127, s[4:7], s92 offen lds
    s_add_u32 m0, s60, 3072
    s_nop 0
    buffer_load_dwordx4 v128, s[4:7], s92 offen lds
    s_add_u32 m0, s60, 16384
    s_nop 0
    buffer_load_dwordx4 v125, s[20:23], s93 offen lds
    s_add_u32 m0, s60, 18432
    s_nop 0
    buffer_load_dwordx4 v126, s[20:23], s93 offen lds
    s_add_u32 s93, s93, 14336
    s_add_u32 m0, s60, 17408
    s_nop 0
    buffer_load_dwordx4 v125, s[20:23], s93 offen lds
    s_add_u32 m0, s60, 19456
    s_nop 0
    buffer_load_dwordx4 v126, s[20:23], s93 offen lds
    s_add_u32 s99, s99, 1
    s_cmp_eq_u32 s99, 7
    s_cselect_b32 s99, 0, s99
    s_lshl_b32 s92, s55, 13
    v_lshrrev_b32 v85, 1, v83
    v_xor_b32 v85, v85, v82
    v_lshlrev_b32 v85, 4, v85
    v_lshl_add_u32 v85, v83, 7, v85
    v_add_u32 v129, s92, v85
    v_xor_b32 v130, 64, v129
    v_bfe_u32 v86, v112, 2, 2
    v_and_b32 v87, 3, v112
    v_lshl_add_u32 v85, v82, 3, v86
    v_lshlrev_b32 v85, 8, v85
    v_lshl_add_u32 v85, v87, 3, v85
    v_add_u32 v85, 16384, v85
    v_and_b32 v118, 1, v82
    v_lshl_add_u32 v118, v118, 2, v86
    s_lshl_b32 s92, s56, 1
    v_xor_b32 v118, s92, v118
    v_lshl_add_u32 v131, v118, 5, v85
    v_xor_b32 v132, 32, v131
    s_mov_b32 s28, s90
    s_and_b32 s29, s91, 0xffff
    s_mov_b32 s30, 16777216
    s_mov_b32 s31, 0x00020000
    s_mov_b32 s24, s82
    s_and_b32 s25, s83, 0xffff
    s_mov_b32 s26, 1605632
    s_mov_b32 s27, 0x00020000
    s_mov_b32 s32, s86
    s_and_b32 s33, s87, 0xffff
    s_mov_b32 s34, 1835008
    s_mov_b32 s35, 0x00020000
    s_lshl_b32 s48, s43, 12
    v_bfe_u32 v85, v80, 1, 1
    v_lshlrev_b32 v85, 2, v85
    v_xor_b32 v85, v85, v81
    v_lshl_add_u32 v85, v85, 4, v84
    s_lshl_b32 s94, s38, 7
    v_add_u32 v120, s94, v85
    v_lshl_add_u32 v85, v82, 2, v86
    v_lshlrev_b32 v85, 7, v85
    v_add_u32 v85, s48, v85
    v_bfe_u32 v118, v86, 1, 1
    v_lshlrev_b32 v118, 2, v118
    v_xor_b32 v118, v118, v87
    s_lshl_b32 s94, s55, 2
    v_xor_b32 v118, s94, v118
    v_lshl_add_u32 v121, v118, 4, v85
    v_xor_b32 v122, 64, v121
    v_add_u32 v123, 0x10000, v121
    v_add_u32 v124, 0x10000, v122
    s_add_u32 s61, s56, s38
    s_and_b32 s61, s61, 3
    s_lshl_b32 s94, s39, 6
    s_lshl_b32 s95, s61, 4
    s_add_u32 s94, s94, s95
    s_mul_i32 s94, s94, 896
    s_lshl_b32 s95, s38, 7
    s_add_u32 s94, s94, s95
    s_lshl_b32 s95, s55, 6
    s_add_u32 s94, s94, s95
    v_mul_u32_u24 v85, 896, v83
    v_lshl_add_u32 v85, v82, 4, v85
    v_add_u32 v119, s94, v85
    s_mov_b32 s46, 0
    s_mov_b32 s47, 0x80000000
    s_mov_b32 s100, s49
    s_mul_i32 s53, s40, 1536
    s_add_u32 s53, s53, 11059200
    s_lshl_b32 s94, s40, 2
    s_load_dword s51, s[74:75], s94
    s_lshl_b32 s94, s42, 8
    s_lshl_b32 s95, s56, 6
    s_add_u32 s94, s94, s95
    v_lshlrev_b32 v85, 3, v82
    v_add_u32 v85, s94, v85
    global_load_dwordx2 v[88:89], v85, s[80:81]
    global_load_dwordx2 v[90:91], v85, s[80:81] offset:32
    buffer_load_dwordx4 v[138:141], v119, s[4:7], 0 offen
    s_barrier
    s_setprio 2
    s_lshl_b32 s92, s99, 7
    s_mul_i32 s93, s99, 229376
    s_add_u32 m0, s60, 32768
    s_nop 0
    buffer_load_dwordx4 v127, s[4:7], s92 offen lds
    s_add_u32 m0, s60, 33792
    s_nop 0
    buffer_load_dwordx4 v128, s[4:7], s92 offen lds
    s_add_u32 s92, s92, 14336
    s_add_u32 m0, s60, 34816
    s_nop 0
    buffer_load_dwordx4 v127, s[4:7], s92 offen lds
    s_add_u32 m0, s60, 35840
    s_nop 0
    buffer_load_dwordx4 v128, s[4:7], s92 offen lds
    s_add_u32 m0, s60, 49152
    s_nop 0
    buffer_load_dwordx4 v125, s[20:23], s93 offen lds
    s_add_u32 m0, s60, 51200
    s_nop 0
    buffer_load_dwordx4 v126, s[20:23], s93 offen lds
    s_add_u32 s93, s93, 14336
    s_add_u32 m0, s60, 50176
    s_nop 0
    buffer_load_dwordx4 v125, s[20:23], s93 offen lds
    s_add_u32 m0, s60, 52224
    s_nop 0
    buffer_load_dwordx4 v126, s[20:23], s93 offen lds
    s_add_u32 s99, s99, 1
    s_cmp_eq_u32 s99, 7
    s_cselect_b32 s99, 0, s99
    s_waitcnt vmcnt(11) lgkmcnt(0)
    s_barrier
    ds_read_b64_tr_b16 v[64:65], v131 offset:0
    ds_read_b64_tr_b16 v[66:67], v131 offset:1024
    ds_read_b64_tr_b16 v[68:69], v132 offset:0
    ds_read_b64_tr_b16 v[70:71], v132 offset:1024
    ds_read_b128 v[32:35], v129 offset:0
    ds_read_b128 v[36:39], v129 offset:2048
    ds_read_b128 v[40:43], v129 offset:4096
    ds_read_b128 v[44:47], v129 offset:6144
    s_waitcnt lgkmcnt(0)
    v_mfma_f32_16x16x32_bf16 v[0:3], v[64:67], v[32:35], 0
    ds_read_b64_tr_b16 v[72:73], v131 offset:8192
    v_mfma_f32_16x16x32_bf16 v[16:19], v[68:71], v[32:35], 0
    ds_read_b64_tr_b16 v[74:75], v131 offset:9216
    s_lshl_b32 s92, s99, 7
    s_mul_i32 s93, s99, 229376
    s_add_u32 m0, s60, 65536
    s_nop 0
    buffer_load_dwordx4 v127, s[4:7], s92 offen lds
    v_mfma_f32_16x16x32_bf16 v[4:7], v[64:67], v[36:39], 0
    ds_read_b64_tr_b16 v[76:77], v132 offset:8192
    v_mfma_f32_16x16x32_bf16 v[20:23], v[68:71], v[36:39], 0
    ds_read_b64_tr_b16 v[78:79], v132 offset:9216
    s_add_u32 m0, s60, 66560
    s_nop 0
    buffer_load_dwordx4 v128, s[4:7], s92 offen lds
    v_mfma_f32_16x16x32_bf16 v[8:11], v[64:67], v[40:43], 0
    ds_read_b128 v[48:51], v130 offset:0
    v_mfma_f32_16x16x32_bf16 v[24:27], v[68:71], v[40:43], 0
    ds_read_b128 v[52:55], v130 offset:2048
    s_add_u32 s92, s92, 14336
    s_add_u32 m0, s60, 67584
    s_nop 0
    buffer_load_dwordx4 v127, s[4:7], s92 offen lds
    v_mfma_f32_16x16x32_bf16 v[12:15], v[64:67], v[44:47], 0
    ds_read_b128 v[56:59], v130 offset:4096
    v_mfma_f32_16x16x32_bf16 v[28:31], v[68:71], v[44:47], 0
    ds_read_b128 v[60:63], v130 offset:6144
    s_add_u32 m0, s60, 68608
    s_nop 0
    buffer_load_dwordx4 v128, s[4:7], s92 offen lds
    s_add_u32 m0, s60, 81920
    s_nop 0
    buffer_load_dwordx4 v125, s[20:23], s93 offen lds
    s_add_u32 m0, s60, 83968
    s_nop 0
    buffer_load_dwordx4 v126, s[20:23], s93 offen lds
    s_add_u32 s93, s93, 14336
    s_add_u32 m0, s60, 82944
    s_nop 0
    buffer_load_dwordx4 v125, s[20:23], s93 offen lds
    s_add_u32 m0, s60, 84992
    s_nop 0
    buffer_load_dwordx4 v126, s[20:23], s93 offen lds
    s_add_u32 s99, s99, 1
    s_cmp_eq_u32 s99, 7
    s_cselect_b32 s99, 0, s99
    s_waitcnt vmcnt(8)
    s_waitcnt lgkmcnt(0)
    s_barrier
    v_mfma_f32_16x16x32_bf16 v[0:3], v[72:75], v[48:51], v[0:3]
    ds_read_b64_tr_b16 v[64:65], v131 offset:32768
    v_mfma_f32_16x16x32_bf16 v[16:19], v[76:79], v[48:51], v[16:19]
    ds_read_b64_tr_b16 v[66:67], v131 offset:33792
    s_lshl_b32 s92, s99, 7
    s_mul_i32 s93, s99, 229376
    s_add_u32 m0, s60, 98304
    s_nop 0
    buffer_load_dwordx4 v127, s[4:7], s92 offen lds
    v_mfma_f32_16x16x32_bf16 v[4:7], v[72:75], v[52:55], v[4:7]
    ds_read_b64_tr_b16 v[68:69], v132 offset:32768
    v_mfma_f32_16x16x32_bf16 v[20:23], v[76:79], v[52:55], v[20:23]
    ds_read_b64_tr_b16 v[70:71], v132 offset:33792
    s_add_u32 m0, s60, 99328
    s_nop 0
    buffer_load_dwordx4 v128, s[4:7], s92 offen lds
    v_mfma_f32_16x16x32_bf16 v[8:11], v[72:75], v[56:59], v[8:11]
    ds_read_b128 v[32:35], v129 offset:32768
    v_mfma_f32_16x16x32_bf16 v[24:27], v[76:79], v[56:59], v[24:27]
    ds_read_b128 v[36:39], v129 offset:34816
    s_add_u32 s92, s92, 14336
    s_add_u32 m0, s60, 100352
    s_nop 0
    buffer_load_dwordx4 v127, s[4:7], s92 offen lds
    v_mfma_f32_16x16x32_bf16 v[12:15], v[72:75], v[60:63], v[12:15]
    ds_read_b128 v[40:43], v129 offset:36864
    v_mfma_f32_16x16x32_bf16 v[28:31], v[76:79], v[60:63], v[28:31]
    ds_read_b128 v[44:47], v129 offset:38912
    s_add_u32 m0, s60, 101376
    s_nop 0
    buffer_load_dwordx4 v128, s[4:7], s92 offen lds
    s_waitcnt lgkmcnt(0)
    v_mfma_f32_16x16x32_bf16 v[0:3], v[64:67], v[32:35], v[0:3]
    ds_read_b64_tr_b16 v[72:73], v131 offset:40960
    v_mfma_f32_16x16x32_bf16 v[16:19], v[68:71], v[32:35], v[16:19]
    ds_read_b64_tr_b16 v[74:75], v131 offset:41984
    s_add_u32 m0, s60, 114688
    s_nop 0
    buffer_load_dwordx4 v125, s[20:23], s93 offen lds
    v_mfma_f32_16x16x32_bf16 v[4:7], v[64:67], v[36:39], v[4:7]
    ds_read_b64_tr_b16 v[76:77], v132 offset:40960
    v_mfma_f32_16x16x32_bf16 v[20:23], v[68:71], v[36:39], v[20:23]
    ds_read_b64_tr_b16 v[78:79], v132 offset:41984
    s_add_u32 m0, s60, 116736
    s_nop 0
    buffer_load_dwordx4 v126, s[20:23], s93 offen lds
    v_mfma_f32_16x16x32_bf16 v[8:11], v[64:67], v[40:43], v[8:11]
    ds_read_b128 v[48:51], v130 offset:32768
    v_mfma_f32_16x16x32_bf16 v[24:27], v[68:71], v[40:43], v[24:27]
    ds_read_b128 v[52:55], v130 offset:34816
    s_add_u32 s93, s93, 14336
    s_add_u32 m0, s60, 115712
    s_nop 0
    buffer_load_dwordx4 v125, s[20:23], s93 offen lds
    v_mfma_f32_16x16x32_bf16 v[12:15], v[64:67], v[44:47], v[12:15]
    ds_read_b128 v[56:59], v130 offset:36864
    v_mfma_f32_16x16x32_bf16 v[28:31], v[68:71], v[44:47], v[28:31]
    ds_read_b128 v[60:63], v130 offset:38912
    s_add_u32 m0, s60, 117760
    s_nop 0
    buffer_load_dwordx4 v126, s[20:23], s93 offen lds
    s_add_u32 s99, s99, 1
    s_cmp_eq_u32 s99, 7
    s_cselect_b32 s99, 0, s99
    s_waitcnt vmcnt(8)
    s_waitcnt lgkmcnt(0)
    s_barrier
    v_xor_b32 v129, 0x10000, v129
    v_xor_b32 v130, 0x10000, v130
    v_xor_b32 v131, 0x10000, v131
    v_xor_b32 v132, 0x10000, v132
    v_mfma_f32_16x16x32_bf16 v[0:3], v[72:75], v[48:51], v[0:3]
    ds_read_b64_tr_b16 v[64:65], v131 offset:0
    v_mfma_f32_16x16x32_bf16 v[16:19], v[76:79], v[48:51], v[16:19]
    ds_read_b64_tr_b16 v[66:67], v131 offset:1024
    s_lshl_b32 s92, s99, 7
    s_mul_i32 s93, s99, 229376
    s_add_u32 m0, s60, 0
    s_nop 0
    buffer_load_dwordx4 v127, s[4:7], s92 offen lds
    v_mfma_f32_16x16x32_bf16 v[4:7], v[72:75], v[52:55], v[4:7]
    ds_read_b64_tr_b16 v[68:69], v132 offset:0
    v_mfma_f32_16x16x32_bf16 v[20:23], v[76:79], v[52:55], v[20:23]
    ds_read_b64_tr_b16 v[70:71], v132 offset:1024
    s_add_u32 m0, s60, 1024
    s_nop 0
    buffer_load_dwordx4 v128, s[4:7], s92 offen lds
    v_mfma_f32_16x16x32_bf16 v[8:11], v[72:75], v[56:59], v[8:11]
    ds_read_b128 v[32:35], v129 offset:0
    v_mfma_f32_16x16x32_bf16 v[24:27], v[76:79], v[56:59], v[24:27]
    ds_read_b128 v[36:39], v129 offset:2048
    s_add_u32 s92, s92, 14336
    s_add_u32 m0, s60, 2048
    s_nop 0
    buffer_load_dwordx4 v127, s[4:7], s92 offen lds
    v_mfma_f32_16x16x32_bf16 v[12:15], v[72:75], v[60:63], v[12:15]
    ds_read_b128 v[40:43], v129 offset:4096
    v_mfma_f32_16x16x32_bf16 v[28:31], v[76:79], v[60:63], v[28:31]
    ds_read_b128 v[44:47], v129 offset:6144
    s_add_u32 m0, s60, 3072
    s_nop 0
    buffer_load_dwordx4 v128, s[4:7], s92 offen lds
    s_waitcnt lgkmcnt(0)
    v_mfma_f32_16x16x32_bf16 v[0:3], v[64:67], v[32:35], v[0:3]
    ds_read_b64_tr_b16 v[72:73], v131 offset:8192
    v_mfma_f32_16x16x32_bf16 v[16:19], v[68:71], v[32:35], v[16:19]
    ds_read_b64_tr_b16 v[74:75], v131 offset:9216
    s_add_u32 m0, s60, 16384
    s_nop 0
    buffer_load_dwordx4 v125, s[20:23], s93 offen lds
    v_mfma_f32_16x16x32_bf16 v[4:7], v[64:67], v[36:39], v[4:7]
    ds_read_b64_tr_b16 v[76:77], v132 offset:8192
    v_mfma_f32_16x16x32_bf16 v[20:23], v[68:71], v[36:39], v[20:23]
    ds_read_b64_tr_b16 v[78:79], v132 offset:9216
    s_add_u32 m0, s60, 18432
    s_nop 0
    buffer_load_dwordx4 v126, s[20:23], s93 offen lds
    v_mfma_f32_16x16x32_bf16 v[8:11], v[64:67], v[40:43], v[8:11]
    ds_read_b128 v[48:51], v130 offset:0
    v_mfma_f32_16x16x32_bf16 v[24:27], v[68:71], v[40:43], v[24:27]
    ds_read_b128 v[52:55], v130 offset:2048
    s_add_u32 s93, s93, 14336
    s_add_u32 m0, s60, 17408
    s_nop 0
    buffer_load_dwordx4 v125, s[20:23], s93 offen lds
    v_mfma_f32_16x16x32_bf16 v[12:15], v[64:67], v[44:47], v[12:15]
    ds_read_b128 v[56:59], v130 offset:4096
    v_mfma_f32_16x16x32_bf16 v[28:31], v[68:71], v[44:47], v[28:31]
    ds_read_b128 v[60:63], v130 offset:6144
    s_add_u32 m0, s60, 19456
    s_nop 0
    buffer_load_dwordx4 v126, s[20:23], s93 offen lds
    s_add_u32 s99, s99, 1
    s_cmp_eq_u32 s99, 7
    s_cselect_b32 s99, 0, s99
    s_waitcnt vmcnt(8)
    s_waitcnt lgkmcnt(0)
    s_barrier
    v_mfma_f32_16x16x32_bf16 v[0:3], v[72:75], v[48:51], v[0:3]
    ds_read_b64_tr_b16 v[64:65], v131 offset:32768
    v_mfma_f32_16x16x32_bf16 v[16:19], v[76:79], v[48:51], v[16:19]
    ds_read_b64_tr_b16 v[66:67], v131 offset:33792
    s_lshl_b32 s92, s99, 7
    s_mul_i32 s93, s99, 229376
    s_add_u32 m0, s60, 32768
    s_nop 0
    buffer_load_dwordx4 v127, s[4:7], s92 offen lds
    v_mfma_f32_16x16x32_bf16 v[4:7], v[72:75], v[52:55], v[4:7]
    ds_read_b64_tr_b16 v[68:69], v132 offset:32768
    v_mfma_f32_16x16x32_bf16 v[20:23], v[76:79], v[52:55], v[20:23]
    ds_read_b64_tr_b16 v[70:71], v132 offset:33792
    s_add_u32 m0, s60, 33792
    s_nop 0
    buffer_load_dwordx4 v128, s[4:7], s92 offen lds
    v_mfma_f32_16x16x32_bf16 v[8:11], v[72:75], v[56:59], v[8:11]
    ds_read_b128 v[32:35], v129 offset:32768
    v_mfma_f32_16x16x32_bf16 v[24:27], v[76:79], v[56:59], v[24:27]
    ds_read_b128 v[36:39], v129 offset:34816
    s_add_u32 s92, s92, 14336
    s_add_u32 m0, s60, 34816
    s_nop 0
    buffer_load_dwordx4 v127, s[4:7], s92 offen lds
    v_mfma_f32_16x16x32_bf16 v[12:15], v[72:75], v[60:63], v[12:15]
    ds_read_b128 v[40:43], v129 offset:36864
    v_mfma_f32_16x16x32_bf16 v[28:31], v[76:79], v[60:63], v[28:31]
    ds_read_b128 v[44:47], v129 offset:38912
    s_add_u32 m0, s60, 35840
    s_nop 0
    buffer_load_dwordx4 v128, s[4:7], s92 offen lds
    s_waitcnt lgkmcnt(0)
    v_mfma_f32_16x16x32_bf16 v[0:3], v[64:67], v[32:35], v[0:3]
    ds_read_b64_tr_b16 v[72:73], v131 offset:40960
    v_mfma_f32_16x16x32_bf16 v[16:19], v[68:71], v[32:35], v[16:19]
    ds_read_b64_tr_b16 v[74:75], v131 offset:41984
    s_add_u32 m0, s60, 49152
    s_nop 0
    buffer_load_dwordx4 v125, s[20:23], s93 offen lds
    v_mfma_f32_16x16x32_bf16 v[4:7], v[64:67], v[36:39], v[4:7]
    ds_read_b64_tr_b16 v[76:77], v132 offset:40960
    v_mfma_f32_16x16x32_bf16 v[20:23], v[68:71], v[36:39], v[20:23]
    ds_read_b64_tr_b16 v[78:79], v132 offset:41984
    s_add_u32 m0, s60, 51200
    s_nop 0
    buffer_load_dwordx4 v126, s[20:23], s93 offen lds
    v_mfma_f32_16x16x32_bf16 v[8:11], v[64:67], v[40:43], v[8:11]
    ds_read_b128 v[48:51], v130 offset:32768
    v_mfma_f32_16x16x32_bf16 v[24:27], v[68:71], v[40:43], v[24:27]
    ds_read_b128 v[52:55], v130 offset:34816
    s_add_u32 s93, s93, 14336
    s_add_u32 m0, s60, 50176
    s_nop 0
    buffer_load_dwordx4 v125, s[20:23], s93 offen lds
    v_mfma_f32_16x16x32_bf16 v[12:15], v[64:67], v[44:47], v[12:15]
    ds_read_b128 v[56:59], v130 offset:36864
    v_mfma_f32_16x16x32_bf16 v[28:31], v[68:71], v[44:47], v[28:31]
    ds_read_b128 v[60:63], v130 offset:38912
    s_add_u32 m0, s60, 52224
    s_nop 0
    buffer_load_dwordx4 v126, s[20:23], s93 offen lds
    s_add_u32 s99, s99, 1
    s_cmp_eq_u32 s99, 7
    s_cselect_b32 s99, 0, s99
    s_waitcnt vmcnt(8)
    s_waitcnt lgkmcnt(0)
    s_barrier
    v_xor_b32 v129, 0x10000, v129
    v_xor_b32 v130, 0x10000, v130
    v_xor_b32 v131, 0x10000, v131
    v_xor_b32 v132, 0x10000, v132
    v_mfma_f32_16x16x32_bf16 v[0:3], v[72:75], v[48:51], v[0:3]
    ds_read_b64_tr_b16 v[64:65], v131 offset:0
    v_mfma_f32_16x16x32_bf16 v[16:19], v[76:79], v[48:51], v[16:19]
    ds_read_b64_tr_b16 v[66:67], v131 offset:1024
    s_lshl_b32 s92, s99, 7
    s_mul_i32 s93, s99, 229376
    s_add_u32 m0, s60, 65536
    s_nop 0
    buffer_load_dwordx4 v127, s[4:7], s92 offen lds
    v_mfma_f32_16x16x32_bf16 v[4:7], v[72:75], v[52:55], v[4:7]
    ds_read_b64_tr_b16 v[68:69], v132 offset:0
    v_mfma_f32_16x16x32_bf16 v[20:23], v[76:79], v[52:55], v[20:23]
    ds_read_b64_tr_b16 v[70:71], v132 offset:1024
    s_add_u32 m0, s60, 66560
    s_nop 0
    buffer_load_dwordx4 v128, s[4:7], s92 offen lds
    v_mfma_f32_16x16x32_bf16 v[8:11], v[72:75], v[56:59], v[8:11]
    ds_read_b128 v[32:35], v129 offset:0
    v_mfma_f32_16x16x32_bf16 v[24:27], v[76:79], v[56:59], v[24:27]
    ds_read_b128 v[36:39], v129 offset:2048
    s_add_u32 s92, s92, 14336
    s_add_u32 m0, s60, 67584
    s_nop 0
    buffer_load_dwordx4 v127, s[4:7], s92 offen lds
    v_mfma_f32_16x16x32_bf16 v[12:15], v[72:75], v[60:63], v[12:15]
    ds_read_b128 v[40:43], v129 offset:4096
    v_mfma_f32_16x16x32_bf16 v[28:31], v[76:79], v[60:63], v[28:31]
    ds_read_b128 v[44:47], v129 offset:6144
    s_add_u32 m0, s60, 68608
    s_nop 0
    buffer_load_dwordx4 v128, s[4:7], s92 offen lds
    s_waitcnt lgkmcnt(0)
    v_mfma_f32_16x16x32_bf16 v[0:3], v[64:67], v[32:35], v[0:3]
    ds_read_b64_tr_b16 v[72:73], v131 offset:8192
    v_mfma_f32_16x16x32_bf16 v[16:19], v[68:71], v[32:35], v[16:19]
    ds_read_b64_tr_b16 v[74:75], v131 offset:9216
    s_add_u32 m0, s60, 81920
    s_nop 0
    buffer_load_dwordx4 v125, s[20:23], s93 offen lds
    v_mfma_f32_16x16x32_bf16 v[4:7], v[64:67], v[36:39], v[4:7]
    ds_read_b64_tr_b16 v[76:77], v132 offset:8192
    v_mfma_f32_16x16x32_bf16 v[20:23], v[68:71], v[36:39], v[20:23]
    ds_read_b64_tr_b16 v[78:79], v132 offset:9216
    s_add_u32 m0, s60, 83968
    s_nop 0
    buffer_load_dwordx4 v126, s[20:23], s93 offen lds
    v_mfma_f32_16x16x32_bf16 v[8:11], v[64:67], v[40:43], v[8:11]
    ds_read_b128 v[48:51], v130 offset:0
    v_mfma_f32_16x16x32_bf16 v[24:27], v[68:71], v[40:43], v[24:27]
    ds_read_b128 v[52:55], v130 offset:2048
    s_add_u32 s93, s93, 14336
    s_add_u32 m0, s60, 82944
    s_nop 0
    buffer_load_dwordx4 v125, s[20:23], s93 offen lds
    v_mfma_f32_16x16x32_bf16 v[12:15], v[64:67], v[44:47], v[12:15]
    ds_read_b128 v[56:59], v130 offset:4096
    v_mfma_f32_16x16x32_bf16 v[28:31], v[68:71], v[44:47], v[28:31]
    ds_read_b128 v[60:63], v130 offset:6144
    s_add_u32 m0, s60, 84992
    s_nop 0
    buffer_load_dwordx4 v126, s[20:23], s93 offen lds
    s_add_u32 s99, s99, 1
    s_cmp_eq_u32 s99, 7
    s_cselect_b32 s99, 0, s99
    s_waitcnt vmcnt(8)
    s_waitcnt lgkmcnt(0)
    s_barrier
    v_mfma_f32_16x16x32_bf16 v[0:3], v[72:75], v[48:51], v[0:3]
    ds_read_b64_tr_b16 v[64:65], v131 offset:32768
    v_mfma_f32_16x16x32_bf16 v[16:19], v[76:79], v[48:51], v[16:19]
    ds_read_b64_tr_b16 v[66:67], v131 offset:33792
    s_mul_i32 s50, s43, 7
    s_add_u32 s50, s50, s100
    s_mul_i32 s50, s50, 28672
    s_add_u32 s100, s100, 1
    s_cmp_eq_u32 s100, 7
    s_cselect_b32 s100, 0, s100
    s_add_u32 m0, s48, 98304
    s_nop 0
    buffer_load_dwordx4 v120, s[24:27], s50 offen lds
    v_mfma_f32_16x16x32_bf16 v[4:7], v[72:75], v[52:55], v[4:7]
    ds_read_b64_tr_b16 v[68:69], v132 offset:32768
    v_mfma_f32_16x16x32_bf16 v[20:23], v[76:79], v[52:55], v[20:23]
    ds_read_b64_tr_b16 v[70:71], v132 offset:33792
    s_add_u32 s50, s50, 7168
    s_add_u32 m0, s48, 99328
    s_nop 0
    buffer_load_dwordx4 v120, s[24:27], s50 offen lds
    v_mfma_f32_16x16x32_bf16 v[8:11], v[72:75], v[56:59], v[8:11]
    ds_read_b128 v[32:35], v129 offset:32768
    v_mfma_f32_16x16x32_bf16 v[24:27], v[76:79], v[56:59], v[24:27]
    ds_read_b128 v[36:39], v129 offset:34816
    s_add_u32 s50, s50, 7168
    s_add_u32 m0, s48, 100352
    s_nop 0
    buffer_load_dwordx4 v120, s[24:27], s50 offen lds
    v_mfma_f32_16x16x32_bf16 v[12:15], v[72:75], v[60:63], v[12:15]
    ds_read_b128 v[40:43], v129 offset:36864
    v_mfma_f32_16x16x32_bf16 v[28:31], v[76:79], v[60:63], v[28:31]
    ds_read_b128 v[44:47], v129 offset:38912
    s_add_u32 s50, s50, 7168
    s_add_u32 m0, s48, 101376
    s_nop 0
    buffer_load_dwordx4 v120, s[24:27], s50 offen lds
    s_waitcnt lgkmcnt(0)
    v_mfma_f32_16x16x32_bf16 v[0:3], v[64:67], v[32:35], v[0:3]
    ds_read_b64_tr_b16 v[72:73], v131 offset:40960
    v_mfma_f32_16x16x32_bf16 v[16:19], v[68:71], v[32:35], v[16:19]
    ds_read_b64_tr_b16 v[74:75], v131 offset:41984
    s_mul_i32 s50, s43, 7
    s_add_u32 s50, s50, s100
    s_mul_i32 s50, s50, 28672
    s_add_u32 s100, s100, 1
    s_cmp_eq_u32 s100, 7
    s_cselect_b32 s100, 0, s100
    s_add_u32 m0, s48, 0
    s_nop 0
    buffer_load_dwordx4 v120, s[24:27], s50 offen lds
    v_mfma_f32_16x16x32_bf16 v[4:7], v[64:67], v[36:39], v[4:7]
    ds_read_b64_tr_b16 v[76:77], v132 offset:40960
    v_mfma_f32_16x16x32_bf16 v[20:23], v[68:71], v[36:39], v[20:23]
    ds_read_b64_tr_b16 v[78:79], v132 offset:41984
    s_add_u32 s50, s50, 7168
    s_add_u32 m0, s48, 1024
    s_nop 0
    buffer_load_dwordx4 v120, s[24:27], s50 offen lds
    v_mfma_f32_16x16x32_bf16 v[8:11], v[64:67], v[40:43], v[8:11]
    ds_read_b128 v[48:51], v130 offset:32768
    v_mfma_f32_16x16x32_bf16 v[24:27], v[68:71], v[40:43], v[24:27]
    ds_read_b128 v[52:55], v130 offset:34816
    s_add_u32 s50, s50, 7168
    s_add_u32 m0, s48, 2048
    s_nop 0
    buffer_load_dwordx4 v120, s[24:27], s50 offen lds
    v_mfma_f32_16x16x32_bf16 v[12:15], v[64:67], v[44:47], v[12:15]
    ds_read_b128 v[56:59], v130 offset:36864
    v_mfma_f32_16x16x32_bf16 v[28:31], v[68:71], v[44:47], v[28:31]
    ds_read_b128 v[60:63], v130 offset:38912
    s_add_u32 s50, s50, 7168
    s_add_u32 m0, s48, 3072
    s_nop 0
    buffer_load_dwordx4 v120, s[24:27], s50 offen lds
    s_waitcnt vmcnt(8)
    s_waitcnt lgkmcnt(0)
    s_barrier
    v_xor_b32 v129, 0x10000, v129
    v_xor_b32 v130, 0x10000, v130
    v_xor_b32 v131, 0x10000, v131
    v_xor_b32 v132, 0x10000, v132
    v_mfma_f32_16x16x32_bf16 v[0:3], v[72:75], v[48:51], v[0:3]
    ds_read_b64_tr_b16 v[64:65], v131 offset:0
    v_mfma_f32_16x16x32_bf16 v[16:19], v[76:79], v[48:51], v[16:19]
    ds_read_b64_tr_b16 v[66:67], v131 offset:1024
    s_mul_i32 s50, s43, 7
    s_add_u32 s50, s50, s100
    s_mul_i32 s50, s50, 28672
    s_add_u32 s100, s100, 1
    s_cmp_eq_u32 s100, 7
    s_cselect_b32 s100, 0, s100
    s_add_u32 m0, s48, 32768
    s_nop 0
    buffer_load_dwordx4 v120, s[24:27], s50 offen lds
    v_mfma_f32_16x16x32_bf16 v[4:7], v[72:75], v[52:55], v[4:7]
    ds_read_b64_tr_b16 v[68:69], v132 offset:0
    v_mfma_f32_16x16x32_bf16 v[20:23], v[76:79], v[52:55], v[20:23]
    ds_read_b64_tr_b16 v[70:71], v132 offset:1024
    s_add_u32 s50, s50, 7168
    s_add_u32 m0, s48, 33792
    s_nop 0
    buffer_load_dwordx4 v120, s[24:27], s50 offen lds
    v_mfma_f32_16x16x32_bf16 v[8:11], v[72:75], v[56:59], v[8:11]
    ds_read_b128 v[32:35], v129 offset:0
    v_mfma_f32_16x16x32_bf16 v[24:27], v[76:79], v[56:59], v[24:27]
    ds_read_b128 v[36:39], v129 offset:2048
    s_add_u32 s50, s50, 7168
    s_add_u32 m0, s48, 34816
    s_nop 0
    buffer_load_dwordx4 v120, s[24:27], s50 offen lds
    v_mfma_f32_16x16x32_bf16 v[12:15], v[72:75], v[60:63], v[12:15]
    ds_read_b128 v[40:43], v129 offset:4096
    v_mfma_f32_16x16x32_bf16 v[28:31], v[76:79], v[60:63], v[28:31]
    ds_read_b128 v[44:47], v129 offset:6144
    s_add_u32 s50, s50, 7168
    s_add_u32 m0, s48, 35840
    s_nop 0
    buffer_load_dwordx4 v120, s[24:27], s50 offen lds
    s_waitcnt lgkmcnt(0)
    v_mfma_f32_16x16x32_bf16 v[0:3], v[64:67], v[32:35], v[0:3]
    ds_read_b64_tr_b16 v[72:73], v131 offset:8192
    v_mfma_f32_16x16x32_bf16 v[16:19], v[68:71], v[32:35], v[16:19]
    ds_read_b64_tr_b16 v[74:75], v131 offset:9216
    v_mfma_f32_16x16x32_bf16 v[4:7], v[64:67], v[36:39], v[4:7]
    ds_read_b64_tr_b16 v[76:77], v132 offset:8192
    v_mfma_f32_16x16x32_bf16 v[20:23], v[68:71], v[36:39], v[20:23]
    ds_read_b64_tr_b16 v[78:79], v132 offset:9216
    v_mfma_f32_16x16x32_bf16 v[8:11], v[64:67], v[40:43], v[8:11]
    ds_read_b128 v[48:51], v130 offset:0
    v_mfma_f32_16x16x32_bf16 v[24:27], v[68:71], v[40:43], v[24:27]
    ds_read_b128 v[52:55], v130 offset:2048
    v_mfma_f32_16x16x32_bf16 v[12:15], v[64:67], v[44:47], v[12:15]
    ds_read_b128 v[56:59], v130 offset:4096
    v_mfma_f32_16x16x32_bf16 v[28:31], v[68:71], v[44:47], v[28:31]
    ds_read_b128 v[60:63], v130 offset:6144
    v_and_b32 v115, 15, v112
    v_lshlrev_b32 v115, 3, v115
    s_lshl_b32 s94, s61, 7
    s_add_u32 s94, s94, 161536
    v_add_u32 v117, s94, v115
    s_lshl_b32 s94, s55, 9
    s_add_u32 s94, s94, 160000
    v_add_u32 v115, s94, v115
    v_lshrrev_b32 v116, 4, v112
    v_lshlrev_b32 v116, 4, v116
    s_lshl_b32 s94, s56, 7
    s_add_u32 s94, s94, 161024
    v_add_u32 v116, s94, v116
    v_mov_b32 v118, 162048
    s_waitcnt lgkmcnt(0)
    s_barrier
    v_mfma_f32_16x16x32_bf16 v[0:3], v[72:75], v[48:51], v[0:3]
    ds_read_b64 v[80:81], v115 offset:0
    v_mfma_f32_16x16x32_bf16 v[16:19], v[76:79], v[48:51], v[16:19]
    ds_read_b64 v[82:83], v115 offset:128
    v_mfma_f32_16x16x32_bf16 v[4:7], v[72:75], v[52:55], v[4:7]
    ds_read_b64 v[84:85], v115 offset:256
    v_mfma_f32_16x16x32_bf16 v[20:23], v[76:79], v[52:55], v[20:23]
    ds_read_b64 v[86:87], v115 offset:384
    v_mfma_f32_16x16x32_bf16 v[8:11], v[72:75], v[56:59], v[8:11]
    ds_read_b128 v[92:95], v116
    v_mfma_f32_16x16x32_bf16 v[24:27], v[76:79], v[56:59], v[24:27]
    ds_read_b128 v[96:99], v116 offset:64
    v_mfma_f32_16x16x32_bf16 v[12:15], v[72:75], v[60:63], v[12:15]
    ds_read_b64 v[134:135], v117
    v_mfma_f32_16x16x32_bf16 v[28:31], v[76:79], v[60:63], v[28:31]
    ds_read_b64 v[102:103], v118
    s_setprio 0
    s_branch L_g1J
L_sync:
    s_lshl_b32 s92, s39, 6
    s_lshl_b32 s93, s56, 3
    s_add_u32 s92, s92, s93
    s_mul_i32 s92, s92, 896
    s_lshl_b32 s93, s38, 7
    s_add_u32 s92, s92, s93
    v_add_u32 v10, s92, v84
    v_xor_b32 v11, s56, v81
    v_lshl_add_u32 v6, v11, 4, v10
    v_xor_b32 v11, 4, v11
    v_lshl_add_u32 v7, v11, 4, v10
    v_add_u32 v7, 28672, v7
    v_subrev_u32 v4, 7168, v6
    v_subrev_u32 v5, 7168, v7
    v_add_u32 v9, 50176, v6
    s_lshl_b32 s95, s56, 10
    s_lshl_b32 s92, s38, 9
    s_lshl_b32 s93, s56, 7
    s_add_u32 s92, s92, s93
    v_lshlrev_b32 v8, 4, v80
    v_add_u32 v8, s92, v8
    s_waitcnt lgkmcnt(0)
    s_mov_b32 s8, s66
    s_and_b32 s9, s67, 0xffff
    s_mov_b32 s10, 1835008
    s_mov_b32 s11, 0x00020000
    s_add_u32 m0, s95, 131072
    s_nop 0
    buffer_load_dwordx4 v4, s[8:11], 0 offen lds
    s_add_u32 m0, s95, 135168
    s_nop 0
    buffer_load_dwordx4 v5, s[8:11], 0 offen lds
    s_mov_b32 s12, s68
    s_and_b32 s13, s69, 0xffff
    s_mov_b32 s14, 1835008
    s_mov_b32 s15, 0x00020000
    s_add_u32 m0, s95, 140288
    s_nop 0
    buffer_load_dwordx4 v6, s[12:15], 0 offen lds
    s_add_u32 m0, s95, 144384
    s_nop 0
    buffer_load_dwordx4 v7, s[12:15], 0 offen lds
    global_load_dwordx4 v[104:107], v8, s[70:71]
    s_cmp_lg_u32 s56, 0
    s_cbranch_scc1 L_nok8
    s_mov_b32 m0, 139264
    s_nop 0
    buffer_load_dwordx4 v9, s[8:11], 0 offen lds
L_nok8:
    s_mov_b32 s28, s90
    s_and_b32 s29, s91, 0xffff
    s_mov_b32 s30, 16777216
    s_mov_b32 s31, 0x00020000
    s_lshl_b32 s92, s56, 1
    v_lshrrev_b32 v10, 2, v80
    v_add_u32 v10, s92, v10
    v_and_b32 v11, 3, v80
    v_lshlrev_b32 v11, 2, v11
    v_lshl_add_u32 v11, v81, 10, v11
    v_add_u32 v11, 131072, v11
    v_xor_b32 v12, v10, v81
    v_lshl_add_u32 v101, v12, 4, v11
    v_add_u32 v13, 1, v81
    v_and_b32 v13, 7, v13
    v_xor_b32 v13, v10, v13
    v_lshl_add_u32 v100, v13, 4, v11
    v_lshlrev_b32 v14, 13, v80
    v_lshl_add_u32 v102, v81, 4, v14
    s_lshl_b32 s58, s38, 18
    s_lshl_b32 s93, s39, 7
    s_add_u32 s58, s58, s93
    s_lshl_b32 s93, s56, 16
    s_add_u32 s58, s58, s93
    s_add_u32 s58, s58, 7340032
    s_add_u32 s59, s58, 4096
    s_lshl_b32 s92, s55, 13
    v_lshrrev_b32 v85, 1, v83
    v_xor_b32 v85, v85, v82
    v_lshlrev_b32 v85, 4, v85
    v_lshl_add_u32 v85, v83, 7, v85
    v_add_u32 v129, s92, v85
    v_xor_b32 v130, 64, v129
    v_bfe_u32 v86, v112, 2, 2
    v_and_b32 v87, 3, v112
    v_lshl_add_u32 v85, v82, 3, v86
    v_lshlrev_b32 v85, 8, v85
    v_lshl_add_u32 v85, v87, 3, v85
    v_add_u32 v85, 16384, v85
    v_and_b32 v118, 1, v82
    v_lshl_add_u32 v118, v118, 2, v86
    s_lshl_b32 s92, s56, 1
    v_xor_b32 v118, s92, v118
    v_lshl_add_u32 v131, v118, 5, v85
    v_xor_b32 v132, 32, v131
    s_mov_b32 s4, s64
    s_and_b32 s5, s65, 0xffff
    s_mov_b32 s6, 1835008
    s_mov_b32 s7, 0x00020000
    s_mov_b32 s16, s72
    s_and_b32 s17, s73, 0xffff
    s_mov_b32 s18, 1835008
    s_mov_b32 s19, 0x00020000
    s_mov_b32 s24, s82
    s_and_b32 s25, s83, 0xffff
    s_mov_b32 s26, 1605632
    s_mov_b32 s27, 0x00020000
    s_mov_b32 s32, s86
    s_and_b32 s33, s87, 0xffff
    s_mov_b32 s34, 1835008
    s_mov_b32 s35, 0x00020000
    s_lshl_b32 s48, s43, 12
    v_bfe_u32 v85, v80, 1, 1
    v_lshlrev_b32 v85, 2, v85
    v_xor_b32 v85, v85, v81
    v_lshl_add_u32 v85, v85, 4, v84
    s_lshl_b32 s94, s38, 7
    v_add_u32 v120, s94, v85
    v_lshl_add_u32 v85, v82, 2, v86
    v_lshlrev_b32 v85, 7, v85
    v_add_u32 v85, s48, v85
    v_bfe_u32 v118, v86, 1, 1
    v_lshlrev_b32 v118, 2, v118
    v_xor_b32 v118, v118, v87
    s_lshl_b32 s94, s55, 2
    v_xor_b32 v118, s94, v118
    v_lshl_add_u32 v121, v118, 4, v85
    v_xor_b32 v122, 64, v121
    v_add_u32 v123, 0x10000, v121
    v_add_u32 v124, 0x10000, v122
    s_add_u32 s61, s56, s38
    s_and_b32 s61, s61, 3
    s_lshl_b32 s94, s39, 6
    s_lshl_b32 s95, s61, 4
    s_add_u32 s94, s94, s95
    s_mul_i32 s94, s94, 896
    s_lshl_b32 s95, s38, 7
    s_add_u32 s94, s94, s95
    s_lshl_b32 s95, s55, 6
    s_add_u32 s94, s94, s95
    v_mul_u32_u24 v85, 896, v83
    v_lshl_add_u32 v85, v82, 4, v85
    v_add_u32 v119, s94, v85
    s_mov_b32 s46, 0
    s_mov_b32 s47, 0x80000000
    s_mov_b32 s100, s49
    s_mul_i32 s53, s40, 1536
    s_add_u32 s53, s53, 11059200
    s_lshl_b32 s94, s40, 2
    s_load_dword s51, s[74:75], s94
    s_lshl_b32 s94, s42, 8
    s_lshl_b32 s95, s56, 6
    s_add_u32 s94, s94, s95
    v_lshlrev_b32 v85, 3, v82
    v_add_u32 v85, s94, v85
    global_load_dwordx2 v[88:89], v85, s[80:81]
    global_load_dwordx2 v[90:91], v85, s[80:81] offset:32
    buffer_load_dwordx4 v[138:141], v119, s[4:7], 0 offen
    s_waitcnt vmcnt(3)
    s_barrier
    ds_read_b32 v0, v101 offset:640
    ds_read_b32 v1, v101 offset:768
    ds_read_b32 v2, v101 offset:896
    ds_read_b32 v3, v100 offset:1024
    ds_read_b32 v4, v100 offset:1152
    ds_read_b32 v5, v100 offset:1280
    ds_read_b32 v6, v100 offset:1408
    ds_read_b32 v7, v100 offset:1536
    ds_read_b32 v8, v100 offset:1664
    ds_read_b32 v9, v100 offset:1792
    ds_read_b32 v10, v100 offset:1920
    ds_read_b32 v11, v101 offset:9216
    ds_read_b32 v12, v101 offset:9344
    ds_read_b32 v13, v101 offset:9472
    ds_read_b32 v14, v101 offset:9600
    ds_read_b32 v15, v101 offset:9728
    ds_read_b32 v16, v101 offset:9856
    ds_read_b32 v17, v101 offset:9984
    ds_read_b32 v18, v101 offset:10112
    v_lshlrev_b32 v20, 16, v104
    v_and_b32 v22, 0xffff0000, v104
    v_lshlrev_b32 v21, 16, v106
    v_and_b32 v23, 0xffff0000, v106
    v_lshlrev_b32 v24, 16, v105
    v_and_b32 v26, 0xffff0000, v105
    v_lshlrev_b32 v25, 16, v107
    v_and_b32 v27, 0xffff0000, v107
    s_waitcnt lgkmcnt(8)
    v_lshlrev_b32 v28, 16, v0
    v_and_b32 v29, 0xffff0000, v0
    v_lshlrev_b32 v30, 16, v1
    v_and_b32 v31, 0xffff0000, v1
    v_lshlrev_b32 v32, 16, v2
    v_and_b32 v33, 0xffff0000, v2
    v_lshlrev_b32 v34, 16, v3
    v_and_b32 v35, 0xffff0000, v3
    v_lshlrev_b32 v36, 16, v4
    v_and_b32 v37, 0xffff0000, v4
    v_lshlrev_b32 v38, 16, v5
    v_and_b32 v39, 0xffff0000, v5
    v_lshlrev_b32 v40, 16, v6
    v_and_b32 v41, 0xffff0000, v6
    v_lshlrev_b32 v42, 16, v7
    v_and_b32 v43, 0xffff0000, v7
    v_lshlrev_b32 v44, 16, v8
    v_and_b32 v45, 0xffff0000, v8
    v_lshlrev_b32 v46, 16, v9
    v_and_b32 v47, 0xffff0000, v9
    v_lshlrev_b32 v48, 16, v10
    v_and_b32 v49, 0xffff0000, v10
    v_pk_mul_f32 v[64:65], v[28:29], v[26:27]
    v_pk_mul_f32 v[66:67], v[30:31], v[26:27]
    v_pk_mul_f32 v[68:69], v[32:33], v[26:27]
    v_pk_mul_f32 v[70:71], v[34:35], v[26:27]
    v_pk_mul_f32 v[72:73], v[36:37], v[26:27]
    v_pk_mul_f32 v[74:75], v[38:39], v[26:27]
    v_pk_mul_f32 v[76:77], v[40:41], v[26:27]
    v_pk_mul_f32 v[78:79], v[42:43], v[26:27]
    v_pk_fma_f32 v[64:65], v[30:31], v[24:25], v[64:65]
    v_pk_fma_f32 v[66:67], v[32:33], v[24:25], v[66:67]
    v_pk_fma_f32 v[68:69], v[34:35], v[24:25], v[68:69]
    v_pk_fma_f32 v[70:71], v[36:37], v[24:25], v[70:71]
    v_pk_fma_f32 v[72:73], v[38:39], v[24:25], v[72:73]
    v_pk_fma_f32 v[74:75], v[40:41], v[24:25], v[74:75]
    v_pk_fma_f32 v[76:77], v[42:43], v[24:25], v[76:77]
    v_pk_fma_f32 v[78:79], v[44:45], v[24:25], v[78:79]
    v_pk_fma_f32 v[64:65], v[32:33], v[22:23], v[64:65]
    v_pk_fma_f32 v[66:67], v[34:35], v[22:23], v[66:67]
    v_pk_fma_f32 v[68:69], v[36:37], v[22:23], v[68:69]
    v_pk_fma_f32 v[70:71], v[38:39], v[22:23], v[70:71]
    v_pk_fma_f32 v[72:73], v[40:41], v[22:23], v[72:73]
    v_pk_fma_f32 v[74:75], v[42:43], v[22:23], v[74:75]
    v_pk_fma_f32 v[76:77], v[44:45], v[22:23], v[76:77]
    v_pk_fma_f32 v[78:79], v[46:47], v[22:23], v[78:79]
    v_pk_fma_f32 v[64:65], v[34:35], v[20:21], v[64:65]
    v_pk_fma_f32 v[66:67], v[36:37], v[20:21], v[66:67]
    v_pk_fma_f32 v[68:69], v[38:39], v[20:21], v[68:69]
    v_pk_fma_f32 v[70:71], v[40:41], v[20:21], v[70:71]
    v_pk_fma_f32 v[72:73], v[42:43], v[20:21], v[72:73]
    v_pk_fma_f32 v[74:75], v[44:45], v[20:21], v[74:75]
    v_pk_fma_f32 v[76:77], v[46:47], v[20:21], v[76:77]
    v_pk_fma_f32 v[78:79], v[48:49], v[20:21], v[78:79]
    s_waitcnt lgkmcnt(0)
    v_lshlrev_b32 v28, 16, v11
    v_and_b32 v29, 0xffff0000, v11
    v_lshlrev_b32 v30, 16, v12
    v_and_b32 v31, 0xffff0000, v12
    v_lshlrev_b32 v32, 16, v13
    v_and_b32 v33, 0xffff0000, v13
    v_lshlrev_b32 v34, 16, v14
    v_and_b32 v35, 0xffff0000, v14
    v_lshlrev_b32 v36, 16, v15
    v_and_b32 v37, 0xffff0000, v15
    v_lshlrev_b32 v38, 16, v16
    v_and_b32 v39, 0xffff0000, v16
    v_lshlrev_b32 v40, 16, v17
    v_and_b32 v41, 0xffff0000, v17
    v_lshlrev_b32 v42, 16, v18
    v_and_b32 v43, 0xffff0000, v18
    v_pk_mul_f32 v[64:65], v[64:65], v[28:29]
    v_pk_mul_f32 v[66:67], v[66:67], v[30:31]
    v_pk_mul_f32 v[68:69], v[68:69], v[32:33]
    v_pk_mul_f32 v[70:71], v[70:71], v[34:35]
    v_pk_mul_f32 v[72:73], v[72:73], v[36:37]
    v_pk_mul_f32 v[74:75], v[74:75], v[38:39]
    v_pk_mul_f32 v[76:77], v[76:77], v[40:41]
    v_pk_mul_f32 v[78:79], v[78:79], v[42:43]
    v_cvt_pk_bf16_f32 v104, v64, v66
    v_cvt_pk_bf16_f32 v105, v68, v70
    v_cvt_pk_bf16_f32 v106, v72, v74
    v_cvt_pk_bf16_f32 v107, v76, v78
    v_cvt_pk_bf16_f32 v108, v65, v67
    v_cvt_pk_bf16_f32 v109, v69, v71
    v_cvt_pk_bf16_f32 v110, v73, v75
    v_cvt_pk_bf16_f32 v111, v77, v79
    buffer_store_dwordx4 v[104:107], v102, s[28:31], s58 offen sc1
    buffer_store_dwordx4 v[108:111], v102, s[28:31], s59 offen sc1
    v_mov_b32 v92, -1
    v_mov_b32 v93, -1
    v_mov_b32 v94, -1
    v_mov_b32 v95, -1
    s_lshl_b32 s92, s40, 13
    s_lshl_b32 s93, s56, 10
    s_add_u32 s92, s92, s93
    s_add_u32 s92, s92, 9175040
    s_add_u32 s93, s92, 4096
    buffer_store_dwordx4 v[92:95], v133, s[28:31], s92 offen sc1
    buffer_store_dwordx4 v[92:95], v133, s[28:31], s93 offen sc1
    v_mov_b32 v96, 0
    global_load_dwordx2 v[98:99], v96, s[88:89] sc1
    s_barrier
    ds_read_b64_tr_b16 v[64:65], v131 offset:0
    ds_read_b64_tr_b16 v[66:67], v131 offset:1024
    ds_read_b64_tr_b16 v[68:69], v132 offset:0
    ds_read_b64_tr_b16 v[70:71], v132 offset:1024
    ds_read_b128 v[32:35], v129 offset:0
    ds_read_b128 v[36:39], v129 offset:2048
    ds_read_b128 v[40:43], v129 offset:4096
    ds_read_b128 v[44:47], v129 offset:6144
    s_waitcnt lgkmcnt(0)
    v_mfma_f32_16x16x32_bf16 v[0:3], v[64:67], v[32:35], 0
    ds_read_b64_tr_b16 v[72:73], v131 offset:8192
    v_mfma_f32_16x16x32_bf16 v[16:19], v[68:71], v[32:35], 0
    ds_read_b64_tr_b16 v[74:75], v131 offset:9216
    v_mfma_f32_16x16x32_bf16 v[4:7], v[64:67], v[36:39], 0
    ds_read_b64_tr_b16 v[76:77], v132 offset:8192
    v_mfma_f32_16x16x32_bf16 v[20:23], v[68:71], v[36:39], 0
    ds_read_b64_tr_b16 v[78:79], v132 offset:9216
    v_mfma_f32_16x16x32_bf16 v[8:11], v[64:67], v[40:43], 0
    ds_read_b128 v[48:51], v130 offset:0
    v_mfma_f32_16x16x32_bf16 v[24:27], v[68:71], v[40:43], 0
    ds_read_b128 v[52:55], v130 offset:2048
    v_mfma_f32_16x16x32_bf16 v[12:15], v[64:67], v[44:47], 0
    ds_read_b128 v[56:59], v130 offset:4096
    v_mfma_f32_16x16x32_bf16 v[28:31], v[68:71], v[44:47], 0
    ds_read_b128 v[60:63], v130 offset:6144
    s_lshl_b32 s92, s40, 13
    s_lshl_b32 s93, s56, 11
    s_add_u32 s92, s92, s93
    v_add_u32 v103, s92, v133
    s_lshr_b32 s92, s56, 1
    s_mul_i32 s92, s92, 4224
    s_and_b32 s93, s56, 1
    s_lshl_b32 s93, s93, 11
    s_add_u32 s92, s92, s93
    s_add_u32 m0, s92, 151680
    s_nop 0
    buffer_load_dwordx4 v103, s[16:19], 0 offen lds
    buffer_load_dwordx4 v103, s[16:19], 0 offen offset:1024 lds
    s_waitcnt lgkmcnt(0)
    s_barrier
    s_cmp_lg_u32 s43, 3
    s_cbranch_scc1 L_nozero
    v_mov_b32 v104, 0
    v_mov_b32 v105, 0
    v_mov_b32 v106, 0
    v_mov_b32 v107, 0
    v_add_u32 v97, 131072, v133
    s_mov_b64 exec, 0xffff
    ds_write_b128 v97, v[104:107]
    ds_write_b128 v97, v[104:107] offset:4352
    s_mov_b64 exec, 0xff
    ds_write_b128 v97, v[104:107] offset:20480
    ds_write_b128 v97, v[104:107] offset:24704
    s_mov_b64 exec, 0xf
    ds_write_b128 v97, v[104:107] offset:31040
    s_mov_b64 exec, 1
    ds_write_b128 v97, v[104:107] offset:10240
    s_mov_b64 exec, -1
L_nozero:
    s_lshl_b32 s59, s38, 5
    s_lshl_b32 s95, s56, 3
    s_add_u32 s59, s59, s95
    s_mul_i32 s59, s59, 1536
    s_lshr_b32 s95, s39, 3
    s_lshl_b32 s95, s95, 7
    s_add_u32 s59, s59, s95
    s_and_b32 s95, s39, 7
    s_lshl_b32 s95, s95, 3
    s_add_u32 s59, s59, s95
    s_add_u32 s59, s59, 11059200
    v_mul_u32_u24 v97, 1536, v112
    s_lshl_b32 s94, s41, 11
    s_lshl_b32 s95, s56, 10
    s_add_u32 s94, s94, s95
    s_lshl_b32 s95, s42, 10
    s_add_u32 s95, s95, 32768
    s_cmp_eq_u32 s56, 2
    s_cselect_b32 s94, s95, s94
    s_lshl_b32 s95, s39, 10
    s_cmp_eq_u32 s56, 3
    s_cselect_b32 s94, s95, s94
    s_add_u32 s58, s94, 11010048
    v_lshlrev_b32 v101, 3, v112
    v_mfma_f32_16x16x32_bf16 v[0:3], v[72:75], v[48:51], v[0:3]
    ds_read_b64_tr_b16 v[64:65], v131 offset:32768
    v_mfma_f32_16x16x32_bf16 v[16:19], v[76:79], v[48:51], v[16:19]
    ds_read_b64_tr_b16 v[66:67], v131 offset:33792
    v_mfma_f32_16x16x32_bf16 v[4:7], v[72:75], v[52:55], v[4:7]
    ds_read_b64_tr_b16 v[68:69], v132 offset:32768
    v_mfma_f32_16x16x32_bf16 v[20:23], v[76:79], v[52:55], v[20:23]
    ds_read_b64_tr_b16 v[70:71], v132 offset:33792
    v_mfma_f32_16x16x32_bf16 v[8:11], v[72:75], v[56:59], v[8:11]
    ds_read_b128 v[32:35], v129 offset:32768
    v_mfma_f32_16x16x32_bf16 v[24:27], v[76:79], v[56:59], v[24:27]
    ds_read_b128 v[36:39], v129 offset:34816
    v_mfma_f32_16x16x32_bf16 v[12:15], v[72:75], v[60:63], v[12:15]
    ds_read_b128 v[40:43], v129 offset:36864
    v_mfma_f32_16x16x32_bf16 v[28:31], v[76:79], v[60:63], v[28:31]
    ds_read_b128 v[44:47], v129 offset:38912
    s_waitcnt lgkmcnt(0)
    v_mfma_f32_16x16x32_bf16 v[0:3], v[64:67], v[32:35], v[0:3]
    ds_read_b64_tr_b16 v[72:73], v131 offset:40960
    v_mfma_f32_16x16x32_bf16 v[16:19], v[68:71], v[32:35], v[16:19]
    ds_read_b64_tr_b16 v[74:75], v131 offset:41984
    v_mfma_f32_16x16x32_bf16 v[4:7], v[64:67], v[36:39], v[4:7]
    ds_read_b64_tr_b16 v[76:77], v132 offset:40960
    v_mfma_f32_16x16x32_bf16 v[20:23], v[68:71], v[36:39], v[20:23]
    ds_read_b64_tr_b16 v[78:79], v132 offset:41984
    v_mfma_f32_16x16x32_bf16 v[8:11], v[64:67], v[40:43], v[8:11]
    ds_read_b128 v[48:51], v130 offset:32768
    v_mfma_f32_16x16x32_bf16 v[24:27], v[68:71], v[40:43], v[24:27]
    ds_read_b128 v[52:55], v130 offset:34816
    v_mfma_f32_16x16x32_bf16 v[12:15], v[64:67], v[44:47], v[12:15]
    ds_read_b128 v[56:59], v130 offset:36864
    v_mfma_f32_16x16x32_bf16 v[28:31], v[68:71], v[44:47], v[28:31]
    ds_read_b128 v[60:63], v130 offset:38912
    s_waitcnt vmcnt(2)
    s_mov_b32 s97, 0
L_chk_non:
    v_cmp_eq_u32 vcc, 0, v98
    s_add_u32 s97, s97, 1
    s_nop 3
    s_cbranch_vccz L_ok_non
    s_cmp_gt_u32 s97, 20000
    s_cbranch_scc1 L_ok_non
    s_sleep 8
    global_load_dwordx2 v[98:99], v96, s[88:89] sc1
    s_waitcnt vmcnt(0)
    s_branch L_chk_non
L_ok_non:
    v_readfirstlane_b32 s98, v98
    v_readfirstlane_b32 s101, v99
    s_mov_b64 exec, 0xff
    buffer_store_dwordx2 v[98:99], v97, s[28:31], s59 offen sc1
    s_mov_b64 exec, 1
    v_mov_b32 v100, 162048
    ds_write_b64 v100, v[98:99]
    s_mov_b64 exec, -1
    s_lshl_b32 s59, s56, 7
    s_add_u32 s59, s59, s53
    v_min_u32 v96, 56, v101
    s_waitcnt lgkmcnt(0)
    s_barrier
    v_xor_b32 v129, 0x10000, v129
    v_xor_b32 v130, 0x10000, v130
    v_xor_b32 v131, 0x10000, v131
    v_xor_b32 v132, 0x10000, v132
    v_mfma_f32_16x16x32_bf16 v[0:3], v[72:75], v[48:51], v[0:3]
    ds_read_b64_tr_b16 v[64:65], v131 offset:0
    v_mfma_f32_16x16x32_bf16 v[16:19], v[76:79], v[48:51], v[16:19]
    ds_read_b64_tr_b16 v[66:67], v131 offset:1024
    v_mfma_f32_16x16x32_bf16 v[4:7], v[72:75], v[52:55], v[4:7]
    ds_read_b64_tr_b16 v[68:69], v132 offset:0
    v_mfma_f32_16x16x32_bf16 v[20:23], v[76:79], v[52:55], v[20:23]
    ds_read_b64_tr_b16 v[70:71], v132 offset:1024
    v_mfma_f32_16x16x32_bf16 v[8:11], v[72:75], v[56:59], v[8:11]
    ds_read_b128 v[32:35], v129 offset:0
    v_mfma_f32_16x16x32_bf16 v[24:27], v[76:79], v[56:59], v[24:27]
    ds_read_b128 v[36:39], v129 offset:2048
    v_mfma_f32_16x16x32_bf16 v[12:15], v[72:75], v[60:63], v[12:15]
    ds_read_b128 v[40:43], v129 offset:4096
    v_mfma_f32_16x16x32_bf16 v[28:31], v[76:79], v[60:63], v[28:31]
    ds_read_b128 v[44:47], v129 offset:6144
    s_waitcnt lgkmcnt(0)
    v_mfma_f32_16x16x32_bf16 v[0:3], v[64:67], v[32:35], v[0:3]
    ds_read_b64_tr_b16 v[72:73], v131 offset:8192
    v_mfma_f32_16x16x32_bf16 v[16:19], v[68:71], v[32:35], v[16:19]
    ds_read_b64_tr_b16 v[74:75], v131 offset:9216
    v_mfma_f32_16x16x32_bf16 v[4:7], v[64:67], v[36:39], v[4:7]
    ds_read_b64_tr_b16 v[76:77], v132 offset:8192
    v_mfma_f32_16x16x32_bf16 v[20:23], v[68:71], v[36:39], v[20:23]
    ds_read_b64_tr_b16 v[78:79], v132 offset:9216
    v_mfma_f32_16x16x32_bf16 v[8:11], v[64:67], v[40:43], v[8:11]
    ds_read_b128 v[48:51], v130 offset:0
    v_mfma_f32_16x16x32_bf16 v[24:27], v[68:71], v[40:43], v[24:27]
    ds_read_b128 v[52:55], v130 offset:2048
    v_mfma_f32_16x16x32_bf16 v[12:15], v[64:67], v[44:47], v[12:15]
    ds_read_b128 v[56:59], v130 offset:4096
    v_mfma_f32_16x16x32_bf16 v[28:31], v[68:71], v[44:47], v[28:31]
    ds_read_b128 v[60:63], v130 offset:6144
    s_waitcnt lgkmcnt(0)
    s_barrier
    v_mfma_f32_16x16x32_bf16 v[0:3], v[72:75], v[48:51], v[0:3]
    ds_read_b64_tr_b16 v[64:65], v131 offset:32768
    v_mfma_f32_16x16x32_bf16 v[16:19], v[76:79], v[48:51], v[16:19]
    ds_read_b64_tr_b16 v[66:67], v131 offset:33792
    v_mfma_f32_16x16x32_bf16 v[4:7], v[72:75], v[52:55], v[4:7]
    ds_read_b64_tr_b16 v[68:69], v132 offset:32768
    v_mfma_f32_16x16x32_bf16 v[20:23], v[76:79], v[52:55], v[20:23]
    ds_read_b64_tr_b16 v[70:71], v132 offset:33792
    v_mfma_f32_16x16x32_bf16 v[8:11], v[72:75], v[56:59], v[8:11]
    ds_read_b128 v[32:35], v129 offset:32768
    v_mfma_f32_16x16x32_bf16 v[24:27], v[76:79], v[56:59], v[24:27]
    ds_read_b128 v[36:39], v129 offset:34816
    v_mfma_f32_16x16x32_bf16 v[12:15], v[72:75], v[60:63], v[12:15]
    ds_read_b128 v[40:43], v129 offset:36864
    v_mfma_f32_16x16x32_bf16 v[28:31], v[76:79], v[60:63], v[28:31]
    ds_read_b128 v[44:47], v129 offset:38912
    s_waitcnt lgkmcnt(0)
    v_mfma_f32_16x16x32_bf16 v[0:3], v[64:67], v[32:35], v[0:3]
    ds_read_b64_tr_b16 v[72:73], v131 offset:40960
    v_mfma_f32_16x16x32_bf16 v[16:19], v[68:71], v[32:35], v[16:19]
    ds_read_b64_tr_b16 v[74:75], v131 offset:41984
    v_mfma_f32_16x16x32_bf16 v[4:7], v[64:67], v[36:39], v[4:7]
    ds_read_b64_tr_b16 v[76:77], v132 offset:40960
    v_mfma_f32_16x16x32_bf16 v[20:23], v[68:71], v[36:39], v[20:23]
    ds_read_b64_tr_b16 v[78:79], v132 offset:41984
    v_mfma_f32_16x16x32_bf16 v[8:11], v[64:67], v[40:43], v[8:11]
    ds_read_b128 v[48:51], v130 offset:32768
    v_mfma_f32_16x16x32_bf16 v[24:27], v[68:71], v[40:43], v[24:27]
    ds_read_b128 v[52:55], v130 offset:34816
    v_mfma_f32_16x16x32_bf16 v[12:15], v[64:67], v[44:47], v[12:15]
    ds_read_b128 v[56:59], v130 offset:36864
    v_mfma_f32_16x16x32_bf16 v[28:31], v[68:71], v[44:47], v[28:31]
    ds_read_b128 v[60:63], v130 offset:38912
    s_waitcnt lgkmcnt(0)
    s_barrier
    v_xor_b32 v129, 0x10000, v129
    v_xor_b32 v130, 0x10000, v130
    v_xor_b32 v131, 0x10000, v131
    v_xor_b32 v132, 0x10000, v132
    v_mfma_f32_16x16x32_bf16 v[0:3], v[72:75], v[48:51], v[0:3]
    ds_read_b64_tr_b16 v[64:65], v131 offset:0
    v_mfma_f32_16x16x32_bf16 v[16:19], v[76:79], v[48:51], v[16:19]
    ds_read_b64_tr_b16 v[66:67], v131 offset:1024
    s_mul_i32 s50, s43, 7
    s_add_u32 s50, s50, s100
    s_mul_i32 s50, s50, 28672
    s_add_u32 s100, s100, 1
    s_cmp_eq_u32 s100, 7
    s_cselect_b32 s100, 0, s100
    s_add_u32 m0, s48, 98304
    s_nop 0
    buffer_load_dwordx4 v120, s[24:27], s50 offen lds
    v_mfma_f32_16x16x32_bf16 v[4:7], v[72:75], v[52:55], v[4:7]
    ds_read_b64_tr_b16 v[68:69], v132 offset:0
    v_mfma_f32_16x16x32_bf16 v[20:23], v[76:79], v[52:55], v[20:23]
    ds_read_b64_tr_b16 v[70:71], v132 offset:1024
    s_add_u32 s50, s50, 7168
    s_add_u32 m0, s48, 99328
    s_nop 0
    buffer_load_dwordx4 v120, s[24:27], s50 offen lds
    v_mfma_f32_16x16x32_bf16 v[8:11], v[72:75], v[56:59], v[8:11]
    ds_read_b128 v[32:35], v129 offset:0
    v_mfma_f32_16x16x32_bf16 v[24:27], v[76:79], v[56:59], v[24:27]
    ds_read_b128 v[36:39], v129 offset:2048
    s_add_u32 s50, s50, 7168
    s_add_u32 m0, s48, 100352
    s_nop 0
    buffer_load_dwordx4 v120, s[24:27], s50 offen lds
    v_mfma_f32_16x16x32_bf16 v[12:15], v[72:75], v[60:63], v[12:15]
    ds_read_b128 v[40:43], v129 offset:4096
    v_mfma_f32_16x16x32_bf16 v[28:31], v[76:79], v[60:63], v[28:31]
    ds_read_b128 v[44:47], v129 offset:6144
    s_add_u32 s50, s50, 7168
    s_add_u32 m0, s48, 101376
    s_nop 0
    buffer_load_dwordx4 v120, s[24:27], s50 offen lds
    s_waitcnt lgkmcnt(0)
    v_mfma_f32_16x16x32_bf16 v[0:3], v[64:67], v[32:35], v[0:3]
    ds_read_b64_tr_b16 v[72:73], v131 offset:8192
    v_mfma_f32_16x16x32_bf16 v[16:19], v[68:71], v[32:35], v[16:19]
    ds_read_b64_tr_b16 v[74:75], v131 offset:9216
    v_mfma_f32_16x16x32_bf16 v[4:7], v[64:67], v[36:39], v[4:7]
    ds_read_b64_tr_b16 v[76:77], v132 offset:8192
    v_mfma_f32_16x16x32_bf16 v[20:23], v[68:71], v[36:39], v[20:23]
    ds_read_b64_tr_b16 v[78:79], v132 offset:9216
    v_mfma_f32_16x16x32_bf16 v[8:11], v[64:67], v[40:43], v[8:11]
    ds_read_b128 v[48:51], v130 offset:0
    v_mfma_f32_16x16x32_bf16 v[24:27], v[68:71], v[40:43], v[24:27]
    ds_read_b128 v[52:55], v130 offset:2048
    v_mfma_f32_16x16x32_bf16 v[12:15], v[64:67], v[44:47], v[12:15]
    ds_read_b128 v[56:59], v130 offset:4096
    v_mfma_f32_16x16x32_bf16 v[28:31], v[68:71], v[44:47], v[28:31]
    ds_read_b128 v[60:63], v130 offset:6144
    s_waitcnt lgkmcnt(0)
    s_barrier
    buffer_load_dwordx4 v[92:95], v133, s[28:31], s58 offen sc1
    buffer_load_dwordx2 v[102:103], v96, s[28:31], s59 offen sc1
    v_mfma_f32_16x16x32_bf16 v[0:3], v[72:75], v[48:51], v[0:3]
    ds_read_b64_tr_b16 v[64:65], v131 offset:32768
    v_mfma_f32_16x16x32_bf16 v[16:19], v[76:79], v[48:51], v[16:19]
    ds_read_b64_tr_b16 v[66:67], v131 offset:33792
    s_mul_i32 s50, s43, 7
    s_add_u32 s50, s50, s100
    s_mul_i32 s50, s50, 28672
    s_add_u32 s100, s100, 1
    s_cmp_eq_u32 s100, 7
    s_cselect_b32 s100, 0, s100
    s_add_u32 m0, s48, 0
    s_nop 0
    buffer_load_dwordx4 v120, s[24:27], s50 offen lds
    v_mfma_f32_16x16x32_bf16 v[4:7], v[72:75], v[52:55], v[4:7]
    ds_read_b64_tr_b16 v[68:69], v132 offset:32768
    v_mfma_f32_16x16x32_bf16 v[20:23], v[76:79], v[52:55], v[20:23]
    ds_read_b64_tr_b16 v[70:71], v132 offset:33792
    s_add_u32 s50, s50, 7168
    s_add_u32 m0, s48, 1024
    s_nop 0
    buffer_load_dwordx4 v120, s[24:27], s50 offen lds
    v_mfma_f32_16x16x32_bf16 v[8:11], v[72:75], v[56:59], v[8:11]
    ds_read_b128 v[32:35], v129 offset:32768
    v_mfma_f32_16x16x32_bf16 v[24:27], v[76:79], v[56:59], v[24:27]
    ds_read_b128 v[36:39], v129 offset:34816
    s_add_u32 s50, s50, 7168
    s_add_u32 m0, s48, 2048
    s_nop 0
    buffer_load_dwordx4 v120, s[24:27], s50 offen lds
    v_mfma_f32_16x16x32_bf16 v[12:15], v[72:75], v[60:63], v[12:15]
    ds_read_b128 v[40:43], v129 offset:36864
    v_mfma_f32_16x16x32_bf16 v[28:31], v[76:79], v[60:63], v[28:31]
    ds_read_b128 v[44:47], v129 offset:38912
    s_add_u32 s50, s50, 7168
    s_add_u32 m0, s48, 3072
    s_nop 0
    buffer_load_dwordx4 v120, s[24:27], s50 offen lds
    s_waitcnt lgkmcnt(0)
    v_mfma_f32_16x16x32_bf16 v[0:3], v[64:67], v[32:35], v[0:3]
    ds_read_b64_tr_b16 v[72:73], v131 offset:40960
    v_mfma_f32_16x16x32_bf16 v[16:19], v[68:71], v[32:35], v[16:19]
    ds_read_b64_tr_b16 v[74:75], v131 offset:41984
    v_mfma_f32_16x16x32_bf16 v[4:7], v[64:67], v[36:39], v[4:7]
    ds_read_b64_tr_b16 v[76:77], v132 offset:40960
    v_mfma_f32_16x16x32_bf16 v[20:23], v[68:71], v[36:39], v[20:23]
    ds_read_b64_tr_b16 v[78:79], v132 offset:41984
    v_mfma_f32_16x16x32_bf16 v[8:11], v[64:67], v[40:43], v[8:11]
    ds_read_b128 v[48:51], v130 offset:32768
    v_mfma_f32_16x16x32_bf16 v[24:27], v[68:71], v[40:43], v[24:27]
    ds_read_b128 v[52:55], v130 offset:34816
    v_mfma_f32_16x16x32_bf16 v[12:15], v[64:67], v[44:47], v[12:15]
    ds_read_b128 v[56:59], v130 offset:36864
    v_mfma_f32_16x16x32_bf16 v[28:31], v[68:71], v[44:47], v[28:31]
    ds_read_b128 v[60:63], v130 offset:38912
    s_waitcnt lgkmcnt(0)
    s_barrier
    v_xor_b32 v129, 0x10000, v129
    v_xor_b32 v130, 0x10000, v130
    v_xor_b32 v131, 0x10000, v131
    v_xor_b32 v132, 0x10000, v132
    v_mfma_f32_16x16x32_bf16 v[0:3], v[72:75], v[48:51], v[0:3]
    ds_read_b64_tr_b16 v[64:65], v131 offset:0
    v_mfma_f32_16x16x32_bf16 v[16:19], v[76:79], v[48:51], v[16:19]
    ds_read_b64_tr_b16 v[66:67], v131 offset:1024
    s_mul_i32 s50, s43, 7
    s_add_u32 s50, s50, s100
    s_mul_i32 s50, s50, 28672
    s_add_u32 s100, s100, 1
    s_cmp_eq_u32 s100, 7
    s_cselect_b32 s100, 0, s100
    s_add_u32 m0, s48, 32768
    s_nop 0
    buffer_load_dwordx4 v120, s[24:27], s50 offen lds
    v_mfma_f32_16x16x32_bf16 v[4:7], v[72:75], v[52:55], v[4:7]
    ds_read_b64_tr_b16 v[68:69], v132 offset:0
    v_mfma_f32_16x16x32_bf16 v[20:23], v[76:79], v[52:55], v[20:23]
    ds_read_b64_tr_b16 v[70:71], v132 offset:1024
    s_add_u32 s50, s50, 7168
    s_add_u32 m0, s48, 33792
    s_nop 0
    buffer_load_dwordx4 v120, s[24:27], s50 offen lds
    v_mfma_f32_16x16x32_bf16 v[8:11], v[72:75], v[56:59], v[8:11]
    ds_read_b128 v[32:35], v129 offset:0
    v_mfma_f32_16x16x32_bf16 v[24:27], v[76:79], v[56:59], v[24:27]
    ds_read_b128 v[36:39], v129 offset:2048
    s_add_u32 s50, s50, 7168
    s_add_u32 m0, s48, 34816
    s_nop 0
    buffer_load_dwordx4 v120, s[24:27], s50 offen lds
    v_mfma_f32_16x16x32_bf16 v[12:15], v[72:75], v[60:63], v[12:15]
    ds_read_b128 v[40:43], v129 offset:4096
    v_mfma_f32_16x16x32_bf16 v[28:31], v[76:79], v[60:63], v[28:31]
    ds_read_b128 v[44:47], v129 offset:6144
    s_add_u32 s50, s50, 7168
    s_add_u32 m0, s48, 35840
    s_nop 0
    buffer_load_dwordx4 v120, s[24:27], s50 offen lds
    s_waitcnt lgkmcnt(0)
    v_mfma_f32_16x16x32_bf16 v[0:3], v[64:67], v[32:35], v[0:3]
    ds_read_b64_tr_b16 v[72:73], v131 offset:8192
    v_mfma_f32_16x16x32_bf16 v[16:19], v[68:71], v[32:35], v[16:19]
    ds_read_b64_tr_b16 v[74:75], v131 offset:9216
    v_mfma_f32_16x16x32_bf16 v[4:7], v[64:67], v[36:39], v[4:7]
    ds_read_b64_tr_b16 v[76:77], v132 offset:8192
    v_mfma_f32_16x16x32_bf16 v[20:23], v[68:71], v[36:39], v[20:23]
    ds_read_b64_tr_b16 v[78:79], v132 offset:9216
    v_mfma_f32_16x16x32_bf16 v[8:11], v[64:67], v[40:43], v[8:11]
    ds_read_b128 v[48:51], v130 offset:0
    v_mfma_f32_16x16x32_bf16 v[24:27], v[68:71], v[40:43], v[24:27]
    ds_read_b128 v[52:55], v130 offset:2048
    v_mfma_f32_16x16x32_bf16 v[12:15], v[64:67], v[44:47], v[12:15]
    ds_read_b128 v[56:59], v130 offset:4096
    v_mfma_f32_16x16x32_bf16 v[28:31], v[68:71], v[44:47], v[28:31]
    ds_read_b128 v[60:63], v130 offset:6144
    s_lshl_b32 s62, s40, 13
    s_lshl_b32 s95, s56, 10
    s_add_u32 s62, s62, s95
    s_add_u32 s62, s62, 7340032
    s_add_u32 s63, s62, 4096
    s_waitcnt vmcnt(8)
    s_mov_b32 s52, 0
    v_xor_b32 v98, s98, v102
    v_xor_b32 v99, s101, v103
    v_or_b32 v98, v98, v99
    v_cmp_ne_u32 vcc, 0, v98
    s_nop 4
    s_cbranch_vccnz L_udef
    buffer_load_dwordx4 v[104:107], v133, s[28:31], s62 offen sc1
    buffer_load_dwordx4 v[108:111], v133, s[28:31], s63 offen sc1
    s_mov_b32 s52, 1
L_udef:
    v_mov_b32 v100, v96
    s_waitcnt vmcnt(9)
    s_mov_b32 s97, 0
L_chk_sm:
    v_xor_b32 v98, s98, v94
    v_xor_b32 v99, s101, v95
    v_or_b32 v98, v98, v99
    v_cmp_ne_u32 vcc, 0, v98
    s_add_u32 s97, s97, 1
    s_nop 3
    s_cbranch_vccz L_ok_sm
    s_cmp_gt_u32 s97, 20000
    s_cbranch_scc1 L_ok_sm
    s_sleep 2
    buffer_load_dwordx4 v[92:95], v133, s[28:31], s58 offen sc1
    s_waitcnt vmcnt(0)
    s_branch L_chk_sm
L_ok_sm:
    s_lshl_b32 s94, s56, 9
    s_add_u32 s94, s94, 160000
    v_add_u32 v101, s94, v101
    ds_write_b64 v101, v[92:93]
    v_and_b32 v115, 15, v112
    v_lshlrev_b32 v115, 3, v115
    s_lshl_b32 s94, s61, 7
    s_add_u32 s94, s94, 161536
    v_add_u32 v117, s94, v115
    s_lshl_b32 s94, s55, 9
    s_add_u32 s94, s94, 160000
    v_add_u32 v115, s94, v115
    v_lshrrev_b32 v116, 4, v112
    v_lshlrev_b32 v116, 4, v116
    s_lshl_b32 s94, s56, 7
    s_add_u32 s94, s94, 161024
    v_add_u32 v116, s94, v116
    v_mov_b32 v118, 162048
    s_waitcnt lgkmcnt(0)
    s_barrier
    v_mfma_f32_16x16x32_bf16 v[0:3], v[72:75], v[48:51], v[0:3]
    ds_read_b64 v[80:81], v115 offset:0
    v_mfma_f32_16x16x32_bf16 v[16:19], v[76:79], v[48:51], v[16:19]
    ds_read_b64 v[82:83], v115 offset:128
    v_mfma_f32_16x16x32_bf16 v[4:7], v[72:75], v[52:55], v[4:7]
    ds_read_b64 v[84:85], v115 offset:256
    v_mfma_f32_16x16x32_bf16 v[20:23], v[76:79], v[52:55], v[20:23]
    ds_read_b64 v[86:87], v115 offset:384
    v_mfma_f32_16x16x32_bf16 v[8:11], v[72:75], v[56:59], v[8:11]
    ds_read_b128 v[92:95], v116
    v_mfma_f32_16x16x32_bf16 v[24:27], v[76:79], v[56:59], v[24:27]
    ds_read_b128 v[96:99], v116 offset:64
    v_mfma_f32_16x16x32_bf16 v[12:15], v[72:75], v[60:63], v[12:15]
    ds_read_b64 v[134:135], v117
    v_mfma_f32_16x16x32_bf16 v[28:31], v[76:79], v[60:63], v[28:31]
    ds_read_b64 v[102:103], v118
L_g1J:
    s_nop 3
    v_lshlrev_b32 v64, 16, v88
    v_and_b32 v65, 0xffff0000, v88
    v_lshlrev_b32 v66, 16, v89
    v_and_b32 v67, 0xffff0000, v89
    v_lshlrev_b32 v68, 16, v90
    v_and_b32 v69, 0xffff0000, v90
    v_lshlrev_b32 v70, 16, v91
    v_and_b32 v71, 0xffff0000, v91
    s_lshl_b32 s92, s41, 3
    s_lshl_b32 s93, s55, 2
    s_add_u32 s92, s92, s93
    s_mul_i32 s92, s92, 56
    s_lshl_b32 s93, s42, 2
    s_add_u32 s92, s92, s93
    s_add_u32 s92, s92, s56
    s_lshl_b32 s92, s92, 10
    s_waitcnt lgkmcnt(0)
    v_readfirstlane_b32 s98, v102
    v_readfirstlane_b32 s101, v103
    v_pk_fma_f32 v[0:1], v[92:93], v[80:81], v[0:1] op_sel:[0,0,0] op_sel_hi:[1,0,1] neg_lo:[1,0,0] neg_hi:[1,0,0]
    v_pk_fma_f32 v[2:3], v[94:95], v[80:81], v[2:3] op_sel:[0,0,0] op_sel_hi:[1,0,1] neg_lo:[1,0,0] neg_hi:[1,0,0]
    v_pk_fma_f32 v[16:17], v[96:97], v[80:81], v[16:17] op_sel:[0,0,0] op_sel_hi:[1,0,1] neg_lo:[1,0,0] neg_hi:[1,0,0]
    v_pk_fma_f32 v[18:19], v[98:99], v[80:81], v[18:19] op_sel:[0,0,0] op_sel_hi:[1,0,1] neg_lo:[1,0,0] neg_hi:[1,0,0]
    v_pk_fma_f32 v[0:1], v[64:65], v[80:81], v[0:1] op_sel:[0,1,0] op_sel_hi:[1,1,1]
    v_pk_fma_f32 v[2:3], v[66:67], v[80:81], v[2:3] op_sel:[0,1,0] op_sel_hi:[1,1,1]
    v_pk_fma_f32 v[16:17], v[68:69], v[80:81], v[16:17] op_sel:[0,1,0] op_sel_hi:[1,1,1]
    v_pk_fma_f32 v[18:19], v[70:71], v[80:81], v[18:19] op_sel:[0,1,0] op_sel_hi:[1,1,1]
    v_max_f32 v0, 0, v0
    v_max_f32 v1, 0, v1
    v_max_f32 v2, 0, v2
    v_max_f32 v3, 0, v3
    v_max_f32 v16, 0, v16
    v_max_f32 v17, 0, v17
    v_max_f32 v18, 0, v18
    v_max_f32 v19, 0, v19
    v_pk_mul_f32 v[0:1], v[0:1], v[0:1]
    v_pk_mul_f32 v[2:3], v[2:3], v[2:3]
    v_pk_mul_f32 v[16:17], v[16:17], v[16:17]
    v_pk_mul_f32 v[18:19], v[18:19], v[18:19]
    v_cvt_pk_bf16_f32 v32, v0, v1
    v_cvt_pk_bf16_f32 v33, v2, v3
    v_cvt_pk_bf16_f32 v34, v16, v17
    v_cvt_pk_bf16_f32 v35, v18, v19
    buffer_store_dwordx4 v[32:35], v133, s[28:31], s92 offen sc1
    s_add_u32 s92, s92, 57344
    v_pk_fma_f32 v[4:5], v[92:93], v[82:83], v[4:5] op_sel:[0,0,0] op_sel_hi:[1,0,1] neg_lo:[1,0,0] neg_hi:[1,0,0]
    v_pk_fma_f32 v[6:7], v[94:95], v[82:83], v[6:7] op_sel:[0,0,0] op_sel_hi:[1,0,1] neg_lo:[1,0,0] neg_hi:[1,0,0]
    v_pk_fma_f32 v[20:21], v[96:97], v[82:83], v[20:21] op_sel:[0,0,0] op_sel_hi:[1,0,1] neg_lo:[1,0,0] neg_hi:[1,0,0]
    v_pk_fma_f32 v[22:23], v[98:99], v[82:83], v[22:23] op_sel:[0,0,0] op_sel_hi:[1,0,1] neg_lo:[1,0,0] neg_hi:[1,0,0]
    v_pk_fma_f32 v[4:5], v[64:65], v[82:83], v[4:5] op_sel:[0,1,0] op_sel_hi:[1,1,1]
    v_pk_fma_f32 v[6:7], v[66:67], v[82:83], v[6:7] op_sel:[0,1,0] op_sel_hi:[1,1,1]
    v_pk_fma_f32 v[20:21], v[68:69], v[82:83], v[20:21] op_sel:[0,1,0] op_sel_hi:[1,1,1]
    v_pk_fma_f32 v[22:23], v[70:71], v[82:83], v[22:23] op_sel:[0,1,0] op_sel_hi:[1,1,1]
    v_max_f32 v4, 0, v4
    v_max_f32 v5, 0, v5
    v_max_f32 v6, 0, v6
    v_max_f32 v7, 0, v7
    v_max_f32 v20, 0, v20
    v_max_f32 v21, 0, v21
    v_max_f32 v22, 0, v22
    v_max_f32 v23, 0, v23
    v_pk_mul_f32 v[4:5], v[4:5], v[4:5]
    v_pk_mul_f32 v[6:7], v[6:7], v[6:7]
    v_pk_mul_f32 v[20:21], v[20:21], v[20:21]
    v_pk_mul_f32 v[22:23], v[22:23], v[22:23]
    v_cvt_pk_bf16_f32 v36, v4, v5
    v_cvt_pk_bf16_f32 v37, v6, v7
    v_cvt_pk_bf16_f32 v38, v20, v21
    v_cvt_pk_bf16_f32 v39, v22, v23
    buffer_store_dwordx4 v[36:39], v133, s[28:31], s92 offen sc1
    s_add_u32 s92, s92, 57344
    v_pk_fma_f32 v[8:9], v[92:93], v[84:85], v[8:9] op_sel:[0,0,0] op_sel_hi:[1,0,1] neg_lo:[1,0,0] neg_hi:[1,0,0]
    v_pk_fma_f32 v[10:11], v[94:95], v[84:85], v[10:11] op_sel:[0,0,0] op_sel_hi:[1,0,1] neg_lo:[1,0,0] neg_hi:[1,0,0]
    v_pk_fma_f32 v[24:25], v[96:97], v[84:85], v[24:25] op_sel:[0,0,0] op_sel_hi:[1,0,1] neg_lo:[1,0,0] neg_hi:[1,0,0]
    v_pk_fma_f32 v[26:27], v[98:99], v[84:85], v[26:27] op_sel:[0,0,0] op_sel_hi:[1,0,1] neg_lo:[1,0,0] neg_hi:[1,0,0]
    v_pk_fma_f32 v[8:9], v[64:65], v[84:85], v[8:9] op_sel:[0,1,0] op_sel_hi:[1,1,1]
    v_pk_fma_f32 v[10:11], v[66:67], v[84:85], v[10:11] op_sel:[0,1,0] op_sel_hi:[1,1,1]
    v_pk_fma_f32 v[24:25], v[68:69], v[84:85], v[24:25] op_sel:[0,1,0] op_sel_hi:[1,1,1]
    v_pk_fma_f32 v[26:27], v[70:71], v[84:85], v[26:27] op_sel:[0,1,0] op_sel_hi:[1,1,1]
    v_max_f32 v8, 0, v8
    v_max_f32 v9, 0, v9
    v_max_f32 v10, 0, v10
    v_max_f32 v11, 0, v11
    v_max_f32 v24, 0, v24
    v_max_f32 v25, 0, v25
    v_max_f32 v26, 0, v26
    v_max_f32 v27, 0, v27
    v_pk_mul_f32 v[8:9], v[8:9], v[8:9]
    v_pk_mul_f32 v[10:11], v[10:11], v[10:11]
    v_pk_mul_f32 v[24:25], v[24:25], v[24:25]
    v_pk_mul_f32 v[26:27], v[26:27], v[26:27]
    v_cvt_pk_bf16_f32 v40, v8, v9
    v_cvt_pk_bf16_f32 v41, v10, v11
    v_cvt_pk_bf16_f32 v42, v24, v25
    v_cvt_pk_bf16_f32 v43, v26, v27
    buffer_store_dwordx4 v[40:43], v133, s[28:31], s92 offen sc1
    s_add_u32 s92, s92, 57344
    v_pk_fma_f32 v[12:13], v[92:93], v[86:87], v[12:13] op_sel:[0,0,0] op_sel_hi:[1,0,1] neg_lo:[1,0,0] neg_hi:[1,0,0]
    v_pk_fma_f32 v[14:15], v[94:95], v[86:87], v[14:15] op_sel:[0,0,0] op_sel_hi:[1,0,1] neg_lo:[1,0,0] neg_hi:[1,0,0]
    v_pk_fma_f32 v[28:29], v[96:97], v[86:87], v[28:29] op_sel:[0,0,0] op_sel_hi:[1,0,1] neg_lo:[1,0,0] neg_hi:[1,0,0]
    v_pk_fma_f32 v[30:31], v[98:99], v[86:87], v[30:31] op_sel:[0,0,0] op_sel_hi:[1,0,1] neg_lo:[1,0,0] neg_hi:[1,0,0]
    v_pk_fma_f32 v[12:13], v[64:65], v[86:87], v[12:13] op_sel:[0,1,0] op_sel_hi:[1,1,1]
    v_pk_fma_f32 v[14:15], v[66:67], v[86:87], v[14:15] op_sel:[0,1,0] op_sel_hi:[1,1,1]
    v_pk_fma_f32 v[28:29], v[68:69], v[86:87], v[28:29] op_sel:[0,1,0] op_sel_hi:[1,1,1]
    v_pk_fma_f32 v[30:31], v[70:71], v[86:87], v[30:31] op_sel:[0,1,0] op_sel_hi:[1,1,1]
    v_max_f32 v12, 0, v12
    v_max_f32 v13, 0, v13
    v_max_f32 v14, 0, v14
    v_max_f32 v15, 0, v15
    v_max_f32 v28, 0, v28
    v_max_f32 v29, 0, v29
    v_max_f32 v30, 0, v30
    v_max_f32 v31, 0, v31
    v_pk_mul_f32 v[12:13], v[12:13], v[12:13]
    v_pk_mul_f32 v[14:15], v[14:15], v[14:15]
    v_pk_mul_f32 v[28:29], v[28:29], v[28:29]
    v_pk_mul_f32 v[30:31], v[30:31], v[30:31]
    v_cvt_pk_bf16_f32 v44, v12, v13
    v_cvt_pk_bf16_f32 v45, v14, v15
    v_cvt_pk_bf16_f32 v46, v28, v29
    v_cvt_pk_bf16_f32 v47, v30, v31
    buffer_store_dwordx4 v[44:47], v133, s[28:31], s92 offen sc1
    s_waitcnt vmcnt(4)
    s_cmp_lg_u32 s55, 0
    s_cbranch_scc1 L_nou
    s_cmp_eq_u32 s52, 1
    s_cbranch_scc1 L_uok
    buffer_load_dwordx2 v[102:103], v100, s[28:31], s59 offen sc1
    s_waitcnt vmcnt(0)
    s_mov_b32 s97, 0
L_chk_mb2:
    v_xor_b32 v98, s98, v102
    v_xor_b32 v99, s101, v103
    v_or_b32 v98, v98, v99
    v_cmp_ne_u32 vcc, 0, v98
    s_add_u32 s97, s97, 1
    s_nop 3
    s_cbranch_vccz L_ok_mb2
    s_cmp_gt_u32 s97, 20000
    s_cbranch_scc1 L_ok_mb2
    s_sleep 6
    buffer_load_dwordx2 v[102:103], v100, s[28:31], s59 offen sc1
    s_waitcnt vmcnt(0)
    s_branch L_chk_mb2
L_ok_mb2:
    buffer_load_dwordx4 v[104:107], v133, s[28:31], s62 offen sc1
    buffer_load_dwordx4 v[108:111], v133, s[28:31], s63 offen sc1
    s_waitcnt vmcnt(0)
L_uok:
    s_lshl_b32 s94, s56, 10
    s_add_u32 s94, s94, 131328
    v_add_u32 v101, s94, v133
    ds_write_b128 v101, v[104:107]
    ds_write_b128 v101, v[108:111] offset:4352
L_nou:
    v_lshrrev_b32 v5, 4, v112
    v_bfe_u32 v6, v112, 2, 2
    v_and_b32 v7, 3, v112
    v_lshlrev_b32 v16, 6, v5
    v_lshl_add_u32 v16, v6, 3, v16
    v_lshl_add_u32 v17, v7, 5, v16
    s_mul_i32 s95, s55, 4224
    s_add_u32 s95, s95, 151584
    v_add_u32 v127, s95, v17
    v_lshlrev_b32 v17, 3, v7
    v_sub_u32 v17, v17, v16
    s_mul_i32 s95, s55, 4352
    s_add_u32 s95, s95, 131392
    v_add_u32 v128, s95, v17
    s_mul_i32 s95, s55, 8192
    s_add_u32 s95, s95, 65536
    v_add_u32 v125, s95, v114
    s_mul_i32 s54, s39, 224
    s_mul_i32 s95, s43, 7
    s_add_u32 s54, s54, s95
    s_sub_u32 s92, 3, s56
    s_cmp_eq_u32 s55, 0
    s_cselect_b32 s96, s56, s92
    s_lshl_b32 s92, s42, 2
    s_add_u32 s92, s92, s56
    s_mul_i32 s93, s92, 37
    s_lshr_b32 s93, s93, 8
    s_mul_i32 s94, s93, 7
    s_sub_u32 s92, s92, s94
    s_lshl_b32 s92, s92, 3
    s_lshl_b32 s93, s93, 7
    s_add_u32 s92, s92, s93
    s_lshl_b32 s58, s41, 1
    s_add_u32 s58, s58, s55
    s_mul_i32 s58, s58, 1536
    s_add_u32 s58, s58, s92
    s_add_u32 s58, s58, 11059712
    s_lshl_b32 s59, s43, 7
    s_add_u32 s59, s59, s53
    v_mul_u32_u24 v115, 49152, v112
    v_lshlrev_b32 v118, 3, v112
    v_min_u32 v118, 48, v118
    v_mov_b32 v130, s98
    v_mov_b32 v131, s101
    s_waitcnt lgkmcnt(0)
    s_barrier
    s_cmp_lg_u32 s96, 0
    s_cbranch_scc1 L_conv1
    ds_read_b64_tr_b16 v[92:93], v128 offset:32
    ds_read_b64_tr_b16 v[94:95], v128 offset:0
    ds_read_b64_tr_b16 v[60:61], v127 offset:0
    ds_read_b64_tr_b16 v[62:63], v127 offset:32
    ds_read_b64_tr_b16 v[64:65], v127 offset:256
    ds_read_b64_tr_b16 v[66:67], v127 offset:288
    ds_read_b64_tr_b16 v[96:97], v128 offset:160
    ds_read_b64_tr_b16 v[98:99], v128 offset:128
    ds_read_b64_tr_b16 v[68:69], v127 offset:512
    ds_read_b64_tr_b16 v[70:71], v127 offset:544
    ds_read_b64_tr_b16 v[100:101], v128 offset:288
    ds_read_b64_tr_b16 v[102:103], v128 offset:256
    s_waitcnt lgkmcnt(10)
    ds_read_b64_tr_b16 v[72:73], v127 offset:768
    ds_read_b64_tr_b16 v[74:75], v127 offset:800
    s_waitcnt lgkmcnt(10)
    v_mfma_f32_16x16x32_bf16 v[0:3], v[60:63], v[92:95], 0
    ds_read_b64_tr_b16 v[104:105], v128 offset:416
    ds_read_b64_tr_b16 v[106:107], v128 offset:384
    ds_read_b64_tr_b16 v[76:77], v127 offset:1024
    ds_read_b64_tr_b16 v[78:79], v127 offset:1056
    s_waitcnt lgkmcnt(12)
    v_mfma_f32_16x16x32_bf16 v[8:11], v[64:67], v[92:95], 0
    ds_read_b64_tr_b16 v[80:81], v127 offset:1280
    ds_read_b64_tr_b16 v[82:83], v127 offset:1312
    s_waitcnt lgkmcnt(10)
    v_mfma_f32_16x16x32_bf16 v[16:19], v[68:71], v[92:95], 0
    ds_read_b64_tr_b16 v[84:85], v127 offset:1536
    ds_read_b64_tr_b16 v[86:87], v127 offset:1568
    s_waitcnt lgkmcnt(8)
    v_mfma_f32_16x16x32_bf16 v[24:27], v[72:75], v[92:95], 0
    ds_read_b64_tr_b16 a[0:1], v123 offset:32768
    ds_read_b64_tr_b16 a[2:3], v123 offset:34816
    ds_read_b64_tr_b16 a[4:5], v123 offset:32776
    ds_read_b64_tr_b16 a[6:7], v123 offset:34824
    ds_read_b64_tr_b16 a[8:9], v124 offset:32768
    ds_read_b64_tr_b16 a[10:11], v124 offset:34816
    ds_read_b64_tr_b16 a[12:13], v124 offset:32776
    ds_read_b64_tr_b16 a[14:15], v124 offset:34824
    ds_read_b64_tr_b16 v[88:89], v127 offset:1792
    ds_read_b64_tr_b16 v[90:91], v127 offset:1824
    s_waitcnt lgkmcnt(14)
    v_mfma_f32_16x16x32_bf16 v[32:35], v[76:79], v[92:95], 0
    s_waitcnt lgkmcnt(12)
    v_mfma_f32_16x16x32_bf16 v[40:43], v[80:83], v[92:95], 0
    s_waitcnt lgkmcnt(10)
    v_mfma_f32_16x16x32_bf16 v[48:51], v[84:87], v[92:95], 0
    s_waitcnt lgkmcnt(0)
    v_mfma_f32_16x16x32_bf16 v[56:59], v[88:91], v[92:95], 0
    ds_read_b64_tr_b16 a[16:17], v121 offset:0
    ds_read_b64_tr_b16 a[18:19], v121 offset:2048
    ds_read_b64_tr_b16 a[20:21], v121 offset:8
    ds_read_b64_tr_b16 a[22:23], v121 offset:2056
    ds_read_b64_tr_b16 a[24:25], v122 offset:0
    ds_read_b64_tr_b16 a[26:27], v122 offset:2048
    ds_read_b64_tr_b16 a[28:29], v122 offset:8
    ds_read_b64_tr_b16 a[30:31], v122 offset:2056
    s_waitcnt lgkmcnt(15)
    v_mfma_f32_16x16x32_bf16 v[4:7], v[60:63], v[96:99], 0
    ds_read_b64_tr_b16 v[92:93], v128 offset:544
    ds_read_b64_tr_b16 v[94:95], v128 offset:512
    v_mfma_f32_16x16x32_bf16 v[12:15], v[64:67], v[96:99], 0
    v_cndmask_b32 v111, v3, 0, s[46:47]
    v_mfma_f32_16x16x32_bf16 v[20:23], v[68:71], v[96:99], 0
    s_nop 0
    v_add_f32_dpp v2, v111, v2 wave_ror:1 row_mask:0xf bank_mask:0xf
    v_mfma_f32_16x16x32_bf16 v[28:31], v[72:75], v[96:99], 0
    v_cndmask_b32 v110, v2, 0, s[46:47]
    ds_read_b64_tr_b16 a[32:33], v121 offset:32768
    ds_read_b64_tr_b16 a[34:35], v121 offset:34816
    ds_read_b64_tr_b16 a[36:37], v121 offset:32776
    ds_read_b64_tr_b16 a[38:39], v121 offset:34824
    ds_read_b64_tr_b16 a[40:41], v122 offset:32768
    ds_read_b64_tr_b16 a[42:43], v122 offset:34816
    ds_read_b64_tr_b16 a[44:45], v122 offset:32776
    ds_read_b64_tr_b16 a[46:47], v122 offset:34824
    v_mfma_f32_16x16x32_bf16 v[36:39], v[76:79], v[96:99], 0
    v_add_f32_dpp v1, v110, v1 wave_ror:1 row_mask:0xf bank_mask:0xf
    v_mfma_f32_16x16x32_bf16 v[44:47], v[80:83], v[96:99], 0
    v_cndmask_b32 v109, v1, 0, s[46:47]
    v_mfma_f32_16x16x32_bf16 v[52:55], v[84:87], v[96:99], 0
    s_nop 0
    v_add_f32_dpp v0, v109, v0 wave_ror:1 row_mask:0xf bank_mask:0xf
    s_waitcnt lgkmcnt(15)
    v_mfma_f32_16x16x32_bf16 v[8:11], v[60:63], v[100:103], v[8:11]
    ds_read_b64_tr_b16 v[96:97], v128 offset:672
    ds_read_b64_tr_b16 v[98:99], v128 offset:640
    s_mul_i32 s50, s43, 7
    s_add_u32 s50, s50, s100
    s_mul_i32 s50, s50, 28672
    s_add_u32 s100, s100, 1
    s_cmp_eq_u32 s100, 7
    s_cselect_b32 s100, 0, s100
    s_waitcnt lgkmcnt(15)
    s_add_u32 m0, s48, 98304
    s_nop 0
    buffer_load_dwordx4 v120, s[24:27], s50 offen lds
    v_mfma_f32_16x16x32_bf16 v[16:19], v[64:67], v[100:103], v[16:19]
    ds_write_b32 v125, v0 offset:0
    v_mfma_f32_16x16x32_bf16 v[24:27], v[68:71], v[100:103], v[24:27]
    v_cndmask_b32 v111, v7, v3, s[46:47]
    s_add_u32 s50, s50, 7168
    s_add_u32 m0, s48, 99328
    s_nop 0
    buffer_load_dwordx4 v120, s[24:27], s50 offen lds
    v_mfma_f32_16x16x32_bf16 v[32:35], v[72:75], v[100:103], v[32:35]
    v_add_f32_dpp v6, v111, v6 wave_ror:1 row_mask:0xf bank_mask:0xf
    v_mfma_f32_16x16x32_bf16 v[40:43], v[76:79], v[100:103], v[40:43]
    v_cndmask_b32 v110, v6, v2, s[46:47]
    s_add_u32 s50, s50, 7168
    s_add_u32 m0, s48, 100352
    s_nop 0
    buffer_load_dwordx4 v120, s[24:27], s50 offen lds
    v_mfma_f32_16x16x32_bf16 v[48:51], v[80:83], v[100:103], v[48:51]
    v_add_f32_dpp v5, v110, v5 wave_ror:1 row_mask:0xf bank_mask:0xf
    v_mfma_f32_16x16x32_bf16 v[56:59], v[84:87], v[100:103], v[56:59]
    v_cndmask_b32 v109, v5, v1, s[46:47]
    s_add_u32 s50, s50, 7168
    s_add_u32 m0, s48, 101376
    s_nop 0
    buffer_load_dwordx4 v120, s[24:27], s50 offen lds
    s_waitcnt lgkmcnt(15)
    v_mfma_f32_16x16x32_bf16 v[12:15], v[60:63], v[104:107], v[12:15]
    ds_read_b64_tr_b16 v[100:101], v128 offset:800
    ds_read_b64_tr_b16 v[102:103], v128 offset:768
    v_mfma_f32_16x16x32_bf16 v[20:23], v[64:67], v[104:107], v[20:23]
    v_add_f32_dpp v4, v109, v4 wave_ror:1 row_mask:0xf bank_mask:0xf
    ds_write_b32 v125, v4 offset:256
    s_mul_i32 s50, s43, 7
    s_add_u32 s50, s50, s100
    s_mul_i32 s50, s50, 28672
    s_add_u32 s100, s100, 1
    s_cmp_eq_u32 s100, 7
    s_cselect_b32 s100, 0, s100
    s_waitcnt lgkmcnt(15)
    s_add_u32 m0, s48, 0
    s_nop 0
    buffer_load_dwordx4 v120, s[24:27], s50 offen lds
    v_mfma_f32_16x16x32_bf16 v[28:31], v[68:71], v[104:107], v[28:31]
    v_cndmask_b32 v111, v11, v7, s[46:47]
    v_mfma_f32_16x16x32_bf16 v[36:39], v[72:75], v[104:107], v[36:39]
    s_nop 0
    v_add_f32_dpp v10, v111, v10 wave_ror:1 row_mask:0xf bank_mask:0xf
    s_add_u32 s50, s50, 7168
    s_add_u32 m0, s48, 1024
    s_nop 0
    buffer_load_dwordx4 v120, s[24:27], s50 offen lds
    v_mfma_f32_16x16x32_bf16 v[44:47], v[76:79], v[104:107], v[44:47]
    v_cndmask_b32 v110, v10, v6, s[46:47]
    v_mfma_f32_16x16x32_bf16 v[52:55], v[80:83], v[104:107], v[52:55]
    s_nop 0
    v_add_f32_dpp v9, v110, v9 wave_ror:1 row_mask:0xf bank_mask:0xf
    s_add_u32 s50, s50, 7168
    s_add_u32 m0, s48, 2048
    s_nop 0
    buffer_load_dwordx4 v120, s[24:27], s50 offen lds
    s_waitcnt lgkmcnt(14)
    v_mfma_f32_16x16x32_bf16 v[16:19], v[60:63], v[92:95], v[16:19]
    ds_read_b64_tr_b16 v[104:105], v128 offset:928
    ds_read_b64_tr_b16 v[106:107], v128 offset:896
    v_mfma_f32_16x16x32_bf16 v[24:27], v[64:67], v[92:95], v[24:27]
    v_cndmask_b32 v109, v9, v5, s[46:47]
    s_nop 1
    v_add_f32_dpp v8, v109, v8 wave_ror:1 row_mask:0xf bank_mask:0xf
    s_add_u32 s50, s50, 7168
    s_add_u32 m0, s48, 3072
    s_nop 0
    buffer_load_dwordx4 v120, s[24:27], s50 offen lds
    v_mfma_f32_16x16x32_bf16 v[32:35], v[68:71], v[92:95], v[32:35]
    ds_write_b32 v125, v8 offset:512
    v_mfma_f32_16x16x32_bf16 v[40:43], v[72:75], v[92:95], v[40:43]
    v_cndmask_b32 v111, v15, v11, s[46:47]
    s_mul_i32 s50, s43, 7
    s_add_u32 s50, s50, s100
    s_mul_i32 s50, s50, 28672
    s_add_u32 s100, s100, 1
    s_cmp_eq_u32 s100, 7
    s_cselect_b32 s100, 0, s100
    s_waitcnt lgkmcnt(9)
    s_add_u32 m0, s48, 32768
    s_nop 0
    buffer_load_dwordx4 v120, s[24:27], s50 offen lds
    v_mfma_f32_16x16x32_bf16 v[48:51], v[76:79], v[92:95], v[48:51]
    v_add_f32_dpp v14, v111, v14 wave_ror:1 row_mask:0xf bank_mask:0xf
    v_mfma_f32_16x16x32_bf16 v[56:59], v[80:83], v[92:95], v[56:59]
    v_cndmask_b32 v110, v14, v10, s[46:47]
    s_add_u32 s50, s50, 7168
    s_add_u32 m0, s48, 33792
    s_nop 0
    buffer_load_dwordx4 v120, s[24:27], s50 offen lds
    s_cmp_lg_u32 s55, 1
    s_cbranch_scc1 L_m2s_0_34
    s_waitcnt vmcnt(10)
    s_mov_b64 exec, 0x7f
    buffer_store_dwordx2 v[130:131], v115, s[28:31], s58 offen sc1
    s_mov_b64 exec, -1
L_m2s_0_34:
    s_waitcnt lgkmcnt(7)
    v_mfma_f32_16x16x32_bf16 v[20:23], v[60:63], v[96:99], v[20:23]
    ds_read_b64_tr_b16 v[92:93], v128 offset:1056
    ds_read_b64_tr_b16 v[94:95], v128 offset:1024
    v_mfma_f32_16x16x32_bf16 v[28:31], v[64:67], v[96:99], v[28:31]
    v_add_f32_dpp v13, v110, v13 wave_ror:1 row_mask:0xf bank_mask:0xf
    v_cndmask_b32 v109, v13, v9, s[46:47]
    s_add_u32 s50, s50, 7168
    s_add_u32 m0, s48, 34816
    s_nop 0
    buffer_load_dwordx4 v120, s[24:27], s50 offen lds
    v_mfma_f32_16x16x32_bf16 v[36:39], v[68:71], v[96:99], v[36:39]
    v_add_f32_dpp v12, v109, v12 wave_ror:1 row_mask:0xf bank_mask:0xf
    ds_write_b32 v125, v12 offset:768
    v_mfma_f32_16x16x32_bf16 v[44:47], v[72:75], v[96:99], v[44:47]
    v_cndmask_b32 v111, v19, v15, s[46:47]
    s_add_u32 s50, s50, 7168
    s_add_u32 m0, s48, 35840
    s_nop 0
    buffer_load_dwordx4 v120, s[24:27], s50 offen lds
    v_mfma_f32_16x16x32_bf16 v[52:55], v[76:79], v[96:99], v[52:55]
    v_add_f32_dpp v18, v111, v18 wave_ror:1 row_mask:0xf bank_mask:0xf
    s_waitcnt lgkmcnt(7)
    v_mfma_f32_16x16x32_bf16 v[24:27], v[60:63], v[100:103], v[24:27]
    ds_read_b64_tr_b16 v[96:97], v128 offset:1184
    ds_read_b64_tr_b16 v[98:99], v128 offset:1152
    v_mfma_f32_16x16x32_bf16 v[32:35], v[64:67], v[100:103], v[32:35]
    v_cndmask_b32 v110, v18, v14, s[46:47]
    s_nop 1
    v_add_f32_dpp v17, v110, v17 wave_ror:1 row_mask:0xf bank_mask:0xf
    v_mfma_f32_16x16x32_bf16 v[40:43], v[68:71], v[100:103], v[40:43]
    v_cndmask_b32 v109, v17, v13, s[46:47]
    s_nop 1
    v_add_f32_dpp v16, v109, v16 wave_ror:1 row_mask:0xf bank_mask:0xf
    v_mfma_f32_16x16x32_bf16 v[48:51], v[72:75], v[100:103], v[48:51]
    ds_write_b32 v125, v16 offset:1024
    v_mfma_f32_16x16x32_bf16 v[56:59], v[76:79], v[100:103], v[56:59]
    v_cndmask_b32 v111, v23, v19, s[46:47]
    s_waitcnt lgkmcnt(7)
    v_mfma_f32_16x16x32_bf16 v[28:31], v[60:63], v[104:107], v[28:31]
    ds_read_b64_tr_b16 v[100:101], v128 offset:1312
    ds_read_b64_tr_b16 v[102:103], v128 offset:1280
    v_mfma_f32_16x16x32_bf16 v[36:39], v[64:67], v[104:107], v[36:39]
    v_add_f32_dpp v22, v111, v22 wave_ror:1 row_mask:0xf bank_mask:0xf
    v_cndmask_b32 v110, v22, v18, s[46:47]
    v_mfma_f32_16x16x32_bf16 v[44:47], v[68:71], v[104:107], v[44:47]
    s_nop 0
    v_add_f32_dpp v21, v110, v21 wave_ror:1 row_mask:0xf bank_mask:0xf
    v_cndmask_b32 v109, v21, v17, s[46:47]
    v_mfma_f32_16x16x32_bf16 v[52:55], v[72:75], v[104:107], v[52:55]
    s_nop 0
    v_add_f32_dpp v20, v109, v20 wave_ror:1 row_mask:0xf bank_mask:0xf
    ds_write_b32 v125, v20 offset:1280
    s_waitcnt lgkmcnt(7)
    v_mfma_f32_16x16x32_bf16 v[32:35], v[60:63], v[92:95], v[32:35]
    ds_read_b64_tr_b16 v[104:105], v128 offset:1440
    ds_read_b64_tr_b16 v[106:107], v128 offset:1408
    v_mfma_f32_16x16x32_bf16 v[40:43], v[64:67], v[92:95], v[40:43]
    v_cndmask_b32 v111, v27, v23, s[46:47]
    s_nop 1
    v_add_f32_dpp v26, v111, v26 wave_ror:1 row_mask:0xf bank_mask:0xf
    s_cmp_lg_u32 s55, 0
    s_cbranch_scc1 L_m2s_0_50
    s_waitcnt vmcnt(12)
    s_mov_b64 exec, 0x7f
    buffer_store_dwordx2 v[130:131], v115, s[28:31], s58 offen sc1
    s_mov_b64 exec, -1
L_m2s_0_50:
    v_mfma_f32_16x16x32_bf16 v[48:51], v[68:71], v[92:95], v[48:51]
    v_cndmask_b32 v110, v26, v22, s[46:47]
    s_nop 1
    v_add_f32_dpp v25, v110, v25 wave_ror:1 row_mask:0xf bank_mask:0xf
    v_mfma_f32_16x16x32_bf16 v[56:59], v[72:75], v[92:95], v[56:59]
    v_cndmask_b32 v109, v25, v21, s[46:47]
    s_nop 1
    v_add_f32_dpp v24, v109, v24 wave_ror:1 row_mask:0xf bank_mask:0xf
    s_waitcnt lgkmcnt(6)
    v_mfma_f32_16x16x32_bf16 v[36:39], v[60:63], v[96:99], v[36:39]
    ds_read_b64_tr_b16 v[92:93], v128 offset:1568
    ds_read_b64_tr_b16 v[94:95], v128 offset:1536
    v_mfma_f32_16x16x32_bf16 v[44:47], v[64:67], v[96:99], v[44:47]
    ds_write_b32 v125, v24 offset:1536
    v_cndmask_b32 v111, v31, v27, s[46:47]
    v_mfma_f32_16x16x32_bf16 v[52:55], v[68:71], v[96:99], v[52:55]
    s_nop 0
    v_add_f32_dpp v30, v111, v30 wave_ror:1 row_mask:0xf bank_mask:0xf
    v_cndmask_b32 v110, v30, v26, s[46:47]
    s_waitcnt lgkmcnt(6)
    v_mfma_f32_16x16x32_bf16 v[40:43], v[60:63], v[100:103], v[40:43]
    ds_read_b64_tr_b16 v[96:97], v128 offset:1696
    ds_read_b64_tr_b16 v[98:99], v128 offset:1664
    v_mfma_f32_16x16x32_bf16 v[48:51], v[64:67], v[100:103], v[48:51]
    v_add_f32_dpp v29, v110, v29 wave_ror:1 row_mask:0xf bank_mask:0xf
    v_cndmask_b32 v109, v29, v25, s[46:47]
    v_mfma_f32_16x16x32_bf16 v[56:59], v[68:71], v[100:103], v[56:59]
    s_nop 0
    v_add_f32_dpp v28, v109, v28 wave_ror:1 row_mask:0xf bank_mask:0xf
    ds_write_b32 v125, v28 offset:1792
    s_waitcnt lgkmcnt(6)
    v_mfma_f32_16x16x32_bf16 v[44:47], v[60:63], v[104:107], v[44:47]
    ds_read_b64_tr_b16 v[100:101], v128 offset:1824
    ds_read_b64_tr_b16 v[102:103], v128 offset:1792
    v_mfma_f32_16x16x32_bf16 v[52:55], v[64:67], v[104:107], v[52:55]
    v_cndmask_b32 v111, v35, v31, s[46:47]
    s_nop 1
    v_add_f32_dpp v34, v111, v34 wave_ror:1 row_mask:0xf bank_mask:0xf
    s_waitcnt lgkmcnt(6)
    v_mfma_f32_16x16x32_bf16 v[48:51], v[60:63], v[92:95], v[48:51]
    v_mfma_f32_16x16x32_bf16 v[56:59], v[64:67], v[92:95], v[56:59]
    v_cndmask_b32 v110, v34, v30, s[46:47]
    s_nop 1
    v_add_f32_dpp v33, v110, v33 wave_ror:1 row_mask:0xf bank_mask:0xf
    s_waitcnt lgkmcnt(3)
    v_mfma_f32_16x16x32_bf16 v[52:55], v[60:63], v[96:99], v[52:55]
    s_waitcnt lgkmcnt(0)
    v_mfma_f32_16x16x32_bf16 v[56:59], v[60:63], v[100:103], v[56:59]
    v_cndmask_b32 v109, v33, v29, s[46:47]
    s_nop 1
    v_add_f32_dpp v32, v109, v32 wave_ror:1 row_mask:0xf bank_mask:0xf
    ds_write_b32 v125, v32 offset:2048
    v_cndmask_b32 v111, v39, v35, s[46:47]
    s_nop 1
    v_add_f32_dpp v38, v111, v38 wave_ror:1 row_mask:0xf bank_mask:0xf
    v_cndmask_b32 v110, v38, v34, s[46:47]
    s_nop 1
    v_add_f32_dpp v37, v110, v37 wave_ror:1 row_mask:0xf bank_mask:0xf
    v_cndmask_b32 v109, v37, v33, s[46:47]
    s_nop 1
    v_add_f32_dpp v36, v109, v36 wave_ror:1 row_mask:0xf bank_mask:0xf
    ds_write_b32 v125, v36 offset:2304
    v_cndmask_b32 v111, v43, v39, s[46:47]
    s_nop 1
    v_add_f32_dpp v42, v111, v42 wave_ror:1 row_mask:0xf bank_mask:0xf
    v_cndmask_b32 v110, v42, v38, s[46:47]
    s_nop 1
    v_add_f32_dpp v41, v110, v41 wave_ror:1 row_mask:0xf bank_mask:0xf
    v_cndmask_b32 v109, v41, v37, s[46:47]
    s_nop 1
    v_add_f32_dpp v40, v109, v40 wave_ror:1 row_mask:0xf bank_mask:0xf
    ds_write_b32 v125, v40 offset:2560
    v_cndmask_b32 v111, v47, v43, s[46:47]
    s_nop 1
    v_add_f32_dpp v46, v111, v46 wave_ror:1 row_mask:0xf bank_mask:0xf
    v_cndmask_b32 v110, v46, v42, s[46:47]
    s_nop 1
    v_add_f32_dpp v45, v110, v45 wave_ror:1 row_mask:0xf bank_mask:0xf
    v_cndmask_b32 v109, v45, v41, s[46:47]
    s_nop 1
    v_add_f32_dpp v44, v109, v44 wave_ror:1 row_mask:0xf bank_mask:0xf
    ds_write_b32 v125, v44 offset:2816
    v_cndmask_b32 v111, v51, v47, s[46:47]
    s_nop 1
    v_add_f32_dpp v50, v111, v50 wave_ror:1 row_mask:0xf bank_mask:0xf
    v_cndmask_b32 v110, v50, v46, s[46:47]
    s_nop 1
    v_add_f32_dpp v49, v110, v49 wave_ror:1 row_mask:0xf bank_mask:0xf
    v_cndmask_b32 v109, v49, v45, s[46:47]
    s_nop 1
    v_add_f32_dpp v48, v109, v48 wave_ror:1 row_mask:0xf bank_mask:0xf
    ds_write_b32 v125, v48 offset:3072
    v_cndmask_b32 v111, v55, v51, s[46:47]
    s_nop 1
    v_add_f32_dpp v54, v111, v54 wave_ror:1 row_mask:0xf bank_mask:0xf
    v_cndmask_b32 v110, v54, v50, s[46:47]
    s_nop 1
    v_add_f32_dpp v53, v110, v53 wave_ror:1 row_mask:0xf bank_mask:0xf
    v_cndmask_b32 v109, v53, v49, s[46:47]
    s_nop 1
    v_add_f32_dpp v52, v109, v52 wave_ror:1 row_mask:0xf bank_mask:0xf
    ds_write_b32 v125, v52 offset:3328
    v_cndmask_b32 v111, v59, v55, s[46:47]
    s_nop 1
    v_add_f32_dpp v58, v111, v58 wave_ror:1 row_mask:0xf bank_mask:0xf
    v_cndmask_b32 v110, v58, v54, s[46:47]
    s_nop 1
    v_add_f32_dpp v57, v110, v57 wave_ror:1 row_mask:0xf bank_mask:0xf
    v_cndmask_b32 v109, v57, v53, s[46:47]
    s_nop 1
    v_add_f32_dpp v56, v109, v56 wave_ror:1 row_mask:0xf bank_mask:0xf
    ds_write_b32 v125, v56 offset:3584
    v_cndmask_b32 v63, 0, v59, s[46:47]
    v_cndmask_b32 v62, 0, v58, s[46:47]
    v_cndmask_b32 v61, 0, v57, s[46:47]
    s_nop 0
    v_add_f32_dpp v62, v63, v62 wave_ror:1 row_mask:0xf bank_mask:0xf
    s_nop 1
    v_add_f32_dpp v61, v62, v61 wave_ror:1 row_mask:0xf bank_mask:0xf
    s_nop 1
    v_mov_b32_dpp v60, v61 wave_ror:1 row_mask:0xf bank_mask:0xf
    s_mul_i32 s92, s55, 768
    s_add_u32 s92, s92, 139776
    v_add_u32 v64, s92, v114
    ds_write_b32 v64, v60
    s_branch L_convJ
L_conv1:
    s_cmp_lg_u32 s96, 1
    s_cbranch_scc1 L_conv2
    ds_read_b64_tr_b16 v[72:73], v128 offset:32
    ds_read_b64_tr_b16 v[74:75], v128 offset:0
    ds_read_b64_tr_b16 v[60:61], v127 offset:2048
    ds_read_b64_tr_b16 v[62:63], v127 offset:2080
    ds_read_b64_tr_b16 v[64:65], v127 offset:2304
    ds_read_b64_tr_b16 v[66:67], v127 offset:2336
    ds_read_b64_tr_b16 v[76:77], v128 offset:160
    ds_read_b64_tr_b16 v[78:79], v128 offset:128
    ds_read_b64_tr_b16 v[68:69], v127 offset:2560
    ds_read_b64_tr_b16 v[70:71], v127 offset:2592
    ds_read_b64_tr_b16 v[80:81], v128 offset:288
    ds_read_b64_tr_b16 v[82:83], v128 offset:256
    ds_read_b64_tr_b16 v[84:85], v128 offset:416
    ds_read_b64_tr_b16 v[86:87], v128 offset:384
    ds_read_b64_tr_b16 v[88:89], v128 offset:544
    ds_read_b64_tr_b16 v[90:91], v128 offset:512
    s_waitcnt lgkmcnt(14)
    ds_read_b64_tr_b16 v[56:57], v127 offset:1792
    ds_read_b64_tr_b16 v[58:59], v127 offset:1824
    s_waitcnt lgkmcnt(14)
    v_mfma_f32_16x16x32_bf16 v[4:7], v[60:63], v[72:75], 0
    ds_read_b64_tr_b16 v[92:93], v128 offset:672
    ds_read_b64_tr_b16 v[94:95], v128 offset:640
    ds_read_b64_tr_b16 v[52:53], v127 offset:1536
    ds_read_b64_tr_b16 v[54:55], v127 offset:1568
    s_waitcnt lgkmcnt(15)
    v_mfma_f32_16x16x32_bf16 v[12:15], v[64:67], v[72:75], 0
    ds_read_b64_tr_b16 v[48:49], v127 offset:1280
    ds_read_b64_tr_b16 v[50:51], v127 offset:1312
    s_waitcnt lgkmcnt(14)
    v_mfma_f32_16x16x32_bf16 v[20:23], v[68:71], v[72:75], 0
    s_waitcnt lgkmcnt(15)
    ds_read_b64_tr_b16 v[44:45], v127 offset:1024
    ds_read_b64_tr_b16 v[46:47], v127 offset:1056
    s_waitcnt lgkmcnt(8)
    v_mfma_f32_16x16x32_bf16 v[0:3], v[56:59], v[76:79], 0
    ds_read_b64_tr_b16 v[72:73], v128 offset:800
    ds_read_b64_tr_b16 v[74:75], v128 offset:768
    ds_read_b64_tr_b16 a[0:1], v123 offset:32768
    ds_read_b64_tr_b16 a[2:3], v123 offset:34816
    ds_read_b64_tr_b16 a[4:5], v123 offset:32776
    ds_read_b64_tr_b16 a[6:7], v123 offset:34824
    ds_read_b64_tr_b16 a[8:9], v124 offset:32768
    ds_read_b64_tr_b16 a[10:11], v124 offset:34816
    ds_read_b64_tr_b16 a[12:13], v124 offset:32776
    ds_read_b64_tr_b16 a[14:15], v124 offset:34824
    ds_read_b64_tr_b16 v[40:41], v127 offset:768
    ds_read_b64_tr_b16 v[42:43], v127 offset:800
    v_mfma_f32_16x16x32_bf16 v[8:11], v[60:63], v[76:79], 0
    ds_read_b64_tr_b16 v[36:37], v127 offset:512
    ds_read_b64_tr_b16 v[38:39], v127 offset:544
    v_mfma_f32_16x16x32_bf16 v[16:19], v[64:67], v[76:79], 0
    ds_read_b64_tr_b16 v[32:33], v127 offset:256
    ds_read_b64_tr_b16 v[34:35], v127 offset:288
    v_mfma_f32_16x16x32_bf16 v[24:27], v[68:71], v[76:79], 0
    s_waitcnt lgkmcnt(15)
    ds_read_b64_tr_b16 v[28:29], v127 offset:0
    ds_read_b64_tr_b16 v[30:31], v127 offset:32
    v_mfma_f32_16x16x32_bf16 v[4:7], v[56:59], v[80:83], v[4:7]
    ds_read_b64_tr_b16 v[76:77], v128 offset:928
    ds_read_b64_tr_b16 v[78:79], v128 offset:896
    ds_read_b64_tr_b16 a[16:17], v121 offset:0
    ds_read_b64_tr_b16 a[18:19], v121 offset:2048
    ds_read_b64_tr_b16 a[20:21], v121 offset:8
    ds_read_b64_tr_b16 a[22:23], v121 offset:2056
    ds_read_b64_tr_b16 a[24:25], v122 offset:0
    ds_read_b64_tr_b16 a[26:27], v122 offset:2048
    ds_read_b64_tr_b16 a[28:29], v122 offset:8
    ds_read_b64_tr_b16 a[30:31], v122 offset:2056
    v_mfma_f32_16x16x32_bf16 v[12:15], v[60:63], v[80:83], v[12:15]
    v_mfma_f32_16x16x32_bf16 v[20:23], v[64:67], v[80:83], v[20:23]
    s_waitcnt lgkmcnt(15)
    s_waitcnt lgkmcnt(15)
    v_mfma_f32_16x16x32_bf16 v[0:3], v[52:55], v[84:87], v[0:3]
    ds_read_b64_tr_b16 v[80:81], v128 offset:1056
    ds_read_b64_tr_b16 v[82:83], v128 offset:1024
    v_mfma_f32_16x16x32_bf16 v[8:11], v[56:59], v[84:87], v[8:11]
    ds_read_b64_tr_b16 a[32:33], v121 offset:32768
    ds_read_b64_tr_b16 a[34:35], v121 offset:34816
    ds_read_b64_tr_b16 a[36:37], v121 offset:32776
    ds_read_b64_tr_b16 a[38:39], v121 offset:34824
    ds_read_b64_tr_b16 a[40:41], v122 offset:32768
    ds_read_b64_tr_b16 a[42:43], v122 offset:34816
    ds_read_b64_tr_b16 a[44:45], v122 offset:32776
    ds_read_b64_tr_b16 a[46:47], v122 offset:34824
    v_mfma_f32_16x16x32_bf16 v[16:19], v[60:63], v[84:87], v[16:19]
    v_mfma_f32_16x16x32_bf16 v[24:27], v[64:67], v[84:87], v[24:27]
    s_waitcnt lgkmcnt(15)
    v_mfma_f32_16x16x32_bf16 v[4:7], v[52:55], v[88:91], v[4:7]
    ds_read_b64_tr_b16 v[84:85], v128 offset:1184
    ds_read_b64_tr_b16 v[86:87], v128 offset:1152
    v_mfma_f32_16x16x32_bf16 v[12:15], v[56:59], v[88:91], v[12:15]
    s_mul_i32 s50, s43, 7
    s_add_u32 s50, s50, s100
    s_mul_i32 s50, s50, 28672
    s_add_u32 s100, s100, 1
    s_cmp_eq_u32 s100, 7
    s_cselect_b32 s100, 0, s100
    s_waitcnt lgkmcnt(15)
    s_add_u32 m0, s48, 98304
    s_nop 0
    buffer_load_dwordx4 v120, s[24:27], s50 offen lds
    v_mfma_f32_16x16x32_bf16 v[20:23], v[60:63], v[88:91], v[20:23]
    s_waitcnt lgkmcnt(15)
    s_waitcnt lgkmcnt(15)
    v_mfma_f32_16x16x32_bf16 v[0:3], v[48:51], v[92:95], v[0:3]
    ds_read_b64_tr_b16 v[88:89], v128 offset:1312
    ds_read_b64_tr_b16 v[90:91], v128 offset:1280
    s_add_u32 s50, s50, 7168
    s_add_u32 m0, s48, 99328
    s_nop 0
    buffer_load_dwordx4 v120, s[24:27], s50 offen lds
    v_mfma_f32_16x16x32_bf16 v[8:11], v[52:55], v[92:95], v[8:11]
    v_mfma_f32_16x16x32_bf16 v[16:19], v[56:59], v[92:95], v[16:19]
    s_add_u32 s50, s50, 7168
    s_add_u32 m0, s48, 100352
    s_nop 0
    buffer_load_dwordx4 v120, s[24:27], s50 offen lds
    v_mfma_f32_16x16x32_bf16 v[24:27], v[60:63], v[92:95], v[24:27]
    s_waitcnt lgkmcnt(15)
    v_mfma_f32_16x16x32_bf16 v[4:7], v[48:51], v[72:75], v[4:7]
    ds_read_b64_tr_b16 v[92:93], v128 offset:1440
    ds_read_b64_tr_b16 v[94:95], v128 offset:1408
    s_add_u32 s50, s50, 7168
    s_add_u32 m0, s48, 101376
    s_nop 0
    buffer_load_dwordx4 v120, s[24:27], s50 offen lds
    v_mfma_f32_16x16x32_bf16 v[12:15], v[52:55], v[72:75], v[12:15]
    v_mfma_f32_16x16x32_bf16 v[20:23], v[56:59], v[72:75], v[20:23]
    s_mul_i32 s50, s43, 7
    s_add_u32 s50, s50, s100
    s_mul_i32 s50, s50, 28672
    s_add_u32 s100, s100, 1
    s_cmp_eq_u32 s100, 7
    s_cselect_b32 s100, 0, s100
    s_waitcnt lgkmcnt(15)
    s_add_u32 m0, s48, 0
    s_nop 0
    buffer_load_dwordx4 v120, s[24:27], s50 offen lds
    s_waitcnt lgkmcnt(15)
    s_waitcnt lgkmcnt(15)
    v_mfma_f32_16x16x32_bf16 v[0:3], v[44:47], v[76:79], v[0:3]
    ds_read_b64_tr_b16 v[72:73], v128 offset:1568
    ds_read_b64_tr_b16 v[74:75], v128 offset:1536
    v_mfma_f32_16x16x32_bf16 v[8:11], v[48:51], v[76:79], v[8:11]
    s_add_u32 s50, s50, 7168
    s_add_u32 m0, s48, 1024
    s_nop 0
    buffer_load_dwordx4 v120, s[24:27], s50 offen lds
    v_mfma_f32_16x16x32_bf16 v[16:19], v[52:55], v[76:79], v[16:19]
    v_mfma_f32_16x16x32_bf16 v[24:27], v[56:59], v[76:79], v[24:27]
    s_add_u32 s50, s50, 7168
    s_add_u32 m0, s48, 2048
    s_nop 0
    buffer_load_dwordx4 v120, s[24:27], s50 offen lds
    s_waitcnt lgkmcnt(15)
    v_mfma_f32_16x16x32_bf16 v[4:7], v[44:47], v[80:83], v[4:7]
    ds_read_b64_tr_b16 v[76:77], v128 offset:1696
    ds_read_b64_tr_b16 v[78:79], v128 offset:1664
    v_mfma_f32_16x16x32_bf16 v[12:15], v[48:51], v[80:83], v[12:15]
    s_add_u32 s50, s50, 7168
    s_add_u32 m0, s48, 3072
    s_nop 0
    buffer_load_dwordx4 v120, s[24:27], s50 offen lds
    v_mfma_f32_16x16x32_bf16 v[20:23], v[52:55], v[80:83], v[20:23]
    s_waitcnt lgkmcnt(8)
    s_waitcnt lgkmcnt(15)
    v_mfma_f32_16x16x32_bf16 v[0:3], v[40:43], v[84:87], v[0:3]
    ds_read_b64_tr_b16 v[80:81], v128 offset:1824
    ds_read_b64_tr_b16 v[82:83], v128 offset:1792
    s_mul_i32 s50, s43, 7
    s_add_u32 s50, s50, s100
    s_mul_i32 s50, s50, 28672
    s_add_u32 s100, s100, 1
    s_cmp_eq_u32 s100, 7
    s_cselect_b32 s100, 0, s100
    s_waitcnt lgkmcnt(12)
    s_add_u32 m0, s48, 32768
    s_nop 0
    buffer_load_dwordx4 v120, s[24:27], s50 offen lds
    v_mfma_f32_16x16x32_bf16 v[8:11], v[44:47], v[84:87], v[8:11]
    v_mfma_f32_16x16x32_bf16 v[16:19], v[48:51], v[84:87], v[16:19]
    s_add_u32 s50, s50, 7168
    s_add_u32 m0, s48, 33792
    s_nop 0
    buffer_load_dwordx4 v120, s[24:27], s50 offen lds
    s_cmp_lg_u32 s55, 1
    s_cbranch_scc1 L_m2s_1_34
    s_waitcnt vmcnt(10)
    s_mov_b64 exec, 0x7f
    buffer_store_dwordx2 v[130:131], v115, s[28:31], s58 offen sc1
    s_mov_b64 exec, -1
L_m2s_1_34:
    v_mfma_f32_16x16x32_bf16 v[24:27], v[52:55], v[84:87], v[24:27]
    s_waitcnt lgkmcnt(8)
    v_mfma_f32_16x16x32_bf16 v[4:7], v[40:43], v[88:91], v[4:7]
    ds_read_b64_tr_b16 v[84:85], v128 offset:1952
    ds_read_b64_tr_b16 v[86:87], v128 offset:1920
    s_add_u32 s50, s50, 7168
    s_add_u32 m0, s48, 34816
    s_nop 0
    buffer_load_dwordx4 v120, s[24:27], s50 offen lds
    v_mfma_f32_16x16x32_bf16 v[12:15], v[44:47], v[88:91], v[12:15]
    v_mfma_f32_16x16x32_bf16 v[20:23], v[48:51], v[88:91], v[20:23]
    s_add_u32 s50, s50, 7168
    s_add_u32 m0, s48, 35840
    s_nop 0
    buffer_load_dwordx4 v120, s[24:27], s50 offen lds
    s_waitcnt lgkmcnt(8)
    s_waitcnt lgkmcnt(15)
    v_mfma_f32_16x16x32_bf16 v[0:3], v[36:39], v[92:95], v[0:3]
    ds_read_b64_tr_b16 v[88:89], v128 offset:2080
    ds_read_b64_tr_b16 v[90:91], v128 offset:2048
    v_mfma_f32_16x16x32_bf16 v[8:11], v[40:43], v[92:95], v[8:11]
    v_mfma_f32_16x16x32_bf16 v[16:19], v[44:47], v[92:95], v[16:19]
    v_mfma_f32_16x16x32_bf16 v[24:27], v[48:51], v[92:95], v[24:27]
    s_waitcnt lgkmcnt(8)
    v_mfma_f32_16x16x32_bf16 v[4:7], v[36:39], v[72:75], v[4:7]
    ds_read_b64_tr_b16 v[92:93], v128 offset:2208
    ds_read_b64_tr_b16 v[94:95], v128 offset:2176
    v_mfma_f32_16x16x32_bf16 v[12:15], v[40:43], v[72:75], v[12:15]
    v_mfma_f32_16x16x32_bf16 v[20:23], v[44:47], v[72:75], v[20:23]
    s_waitcnt lgkmcnt(8)
    s_waitcnt lgkmcnt(15)
    v_mfma_f32_16x16x32_bf16 v[0:3], v[32:35], v[76:79], v[0:3]
    ds_read_b64_tr_b16 v[72:73], v128 offset:2336
    ds_read_b64_tr_b16 v[74:75], v128 offset:2304
    v_mfma_f32_16x16x32_bf16 v[8:11], v[36:39], v[76:79], v[8:11]
    v_mfma_f32_16x16x32_bf16 v[16:19], v[40:43], v[76:79], v[16:19]
    v_mfma_f32_16x16x32_bf16 v[24:27], v[44:47], v[76:79], v[24:27]
    s_waitcnt lgkmcnt(8)
    v_mfma_f32_16x16x32_bf16 v[4:7], v[32:35], v[80:83], v[4:7]
    ds_read_b64_tr_b16 v[76:77], v128 offset:2464
    ds_read_b64_tr_b16 v[78:79], v128 offset:2432
    s_cmp_lg_u32 s55, 0
    s_cbranch_scc1 L_m2s_1_50
    s_waitcnt vmcnt(12)
    s_mov_b64 exec, 0x7f
    buffer_store_dwordx2 v[130:131], v115, s[28:31], s58 offen sc1
    s_mov_b64 exec, -1
L_m2s_1_50:
    v_mfma_f32_16x16x32_bf16 v[12:15], v[36:39], v[80:83], v[12:15]
    v_mfma_f32_16x16x32_bf16 v[20:23], v[40:43], v[80:83], v[20:23]
    s_waitcnt lgkmcnt(8)
    s_waitcnt lgkmcnt(15)
    v_mfma_f32_16x16x32_bf16 v[0:3], v[28:31], v[84:87], v[0:3]
    ds_read_b64_tr_b16 v[80:81], v128 offset:2592
    ds_read_b64_tr_b16 v[82:83], v128 offset:2560
    v_mfma_f32_16x16x32_bf16 v[8:11], v[32:35], v[84:87], v[8:11]
    v_mfma_f32_16x16x32_bf16 v[16:19], v[36:39], v[84:87], v[16:19]
    v_mfma_f32_16x16x32_bf16 v[24:27], v[40:43], v[84:87], v[24:27]
    s_waitcnt lgkmcnt(8)
    v_mfma_f32_16x16x32_bf16 v[4:7], v[28:31], v[88:91], v[4:7]
    ds_read_b64_tr_b16 v[84:85], v128 offset:2720
    ds_read_b64_tr_b16 v[86:87], v128 offset:2688
    v_mfma_f32_16x16x32_bf16 v[12:15], v[32:35], v[88:91], v[12:15]
    v_cndmask_b32 v99, v3, 0, s[46:47]
    v_mfma_f32_16x16x32_bf16 v[20:23], v[36:39], v[88:91], v[20:23]
    s_nop 0
    v_add_f32_dpp v2, v99, v2 wave_ror:1 row_mask:0xf bank_mask:0xf
    s_waitcnt lgkmcnt(8)
    v_mfma_f32_16x16x32_bf16 v[8:11], v[28:31], v[92:95], v[8:11]
    v_mfma_f32_16x16x32_bf16 v[16:19], v[32:35], v[92:95], v[16:19]
    v_cndmask_b32 v98, v2, 0, s[46:47]
    s_nop 1
    v_add_f32_dpp v1, v98, v1 wave_ror:1 row_mask:0xf bank_mask:0xf
    v_mfma_f32_16x16x32_bf16 v[24:27], v[36:39], v[92:95], v[24:27]
    v_cndmask_b32 v97, v1, 0, s[46:47]
    s_nop 1
    v_add_f32_dpp v0, v97, v0 wave_ror:1 row_mask:0xf bank_mask:0xf
    s_waitcnt lgkmcnt(6)
    v_mfma_f32_16x16x32_bf16 v[12:15], v[28:31], v[72:75], v[12:15]
    v_mfma_f32_16x16x32_bf16 v[20:23], v[32:35], v[72:75], v[20:23]
    ds_write_b32 v125, v0 offset:3840
    v_cndmask_b32 v99, v7, v3, s[46:47]
    s_waitcnt lgkmcnt(5)
    v_mfma_f32_16x16x32_bf16 v[16:19], v[28:31], v[76:79], v[16:19]
    v_mfma_f32_16x16x32_bf16 v[24:27], v[32:35], v[76:79], v[24:27]
    v_add_f32_dpp v6, v99, v6 wave_ror:1 row_mask:0xf bank_mask:0xf
    v_cndmask_b32 v98, v6, v2, s[46:47]
    s_waitcnt lgkmcnt(3)
    v_mfma_f32_16x16x32_bf16 v[20:23], v[28:31], v[80:83], v[20:23]
    s_waitcnt lgkmcnt(1)
    v_mfma_f32_16x16x32_bf16 v[24:27], v[28:31], v[84:87], v[24:27]
    v_add_f32_dpp v5, v98, v5 wave_ror:1 row_mask:0xf bank_mask:0xf
    v_cndmask_b32 v97, v5, v1, s[46:47]
    s_nop 1
    v_add_f32_dpp v4, v97, v4 wave_ror:1 row_mask:0xf bank_mask:0xf
    ds_write_b32 v125, v4 offset:4096
    v_cndmask_b32 v99, v11, v7, s[46:47]
    s_nop 1
    v_add_f32_dpp v10, v99, v10 wave_ror:1 row_mask:0xf bank_mask:0xf
    v_cndmask_b32 v98, v10, v6, s[46:47]
    s_nop 1
    v_add_f32_dpp v9, v98, v9 wave_ror:1 row_mask:0xf bank_mask:0xf
    v_cndmask_b32 v97, v9, v5, s[46:47]
    s_nop 1
    v_add_f32_dpp v8, v97, v8 wave_ror:1 row_mask:0xf bank_mask:0xf
    ds_write_b32 v125, v8 offset:4352
    v_cndmask_b32 v99, v15, v11, s[46:47]
    s_nop 1
    v_add_f32_dpp v14, v99, v14 wave_ror:1 row_mask:0xf bank_mask:0xf
    v_cndmask_b32 v98, v14, v10, s[46:47]
    s_nop 1
    v_add_f32_dpp v13, v98, v13 wave_ror:1 row_mask:0xf bank_mask:0xf
    v_cndmask_b32 v97, v13, v9, s[46:47]
    s_nop 1
    v_add_f32_dpp v12, v97, v12 wave_ror:1 row_mask:0xf bank_mask:0xf
    ds_write_b32 v125, v12 offset:4608
    v_cndmask_b32 v99, v19, v15, s[46:47]
    s_nop 1
    v_add_f32_dpp v18, v99, v18 wave_ror:1 row_mask:0xf bank_mask:0xf
    v_cndmask_b32 v98, v18, v14, s[46:47]
    s_nop 1
    v_add_f32_dpp v17, v98, v17 wave_ror:1 row_mask:0xf bank_mask:0xf
    v_cndmask_b32 v97, v17, v13, s[46:47]
    s_nop 1
    v_add_f32_dpp v16, v97, v16 wave_ror:1 row_mask:0xf bank_mask:0xf
    ds_write_b32 v125, v16 offset:4864
    v_cndmask_b32 v99, v23, v19, s[46:47]
    s_nop 1
    v_add_f32_dpp v22, v99, v22 wave_ror:1 row_mask:0xf bank_mask:0xf
    v_cndmask_b32 v98, v22, v18, s[46:47]
    s_nop 1
    v_add_f32_dpp v21, v98, v21 wave_ror:1 row_mask:0xf bank_mask:0xf
    v_cndmask_b32 v97, v21, v17, s[46:47]
    s_nop 1
    v_add_f32_dpp v20, v97, v20 wave_ror:1 row_mask:0xf bank_mask:0xf
    ds_write_b32 v125, v20 offset:5120
    v_cndmask_b32 v99, v27, v23, s[46:47]
    s_nop 1
    v_add_f32_dpp v26, v99, v26 wave_ror:1 row_mask:0xf bank_mask:0xf
    v_cndmask_b32 v98, v26, v22, s[46:47]
    s_nop 1
    v_add_f32_dpp v25, v98, v25 wave_ror:1 row_mask:0xf bank_mask:0xf
    v_cndmask_b32 v97, v25, v21, s[46:47]
    s_nop 1
    v_add_f32_dpp v24, v97, v24 wave_ror:1 row_mask:0xf bank_mask:0xf
    ds_write_b32 v125, v24 offset:5376
    v_cndmask_b32 v31, 0, v27, s[46:47]
    v_cndmask_b32 v30, 0, v26, s[46:47]
    v_cndmask_b32 v29, 0, v25, s[46:47]
    s_nop 0
    v_add_f32_dpp v30, v31, v30 wave_ror:1 row_mask:0xf bank_mask:0xf
    s_nop 1
    v_add_f32_dpp v29, v30, v29 wave_ror:1 row_mask:0xf bank_mask:0xf
    s_nop 1
    v_mov_b32_dpp v28, v29 wave_ror:1 row_mask:0xf bank_mask:0xf
    s_mul_i32 s92, s55, 768
    s_add_u32 s92, s92, 140032
    v_add_u32 v32, s92, v114
    ds_write_b32 v32, v28
    s_branch L_convJ
L_conv2:
    s_cmp_lg_u32 s96, 2
    s_cbranch_scc1 L_conv3
    ds_read_b64_tr_b16 v[76:77], v128 offset:32
    ds_read_b64_tr_b16 v[78:79], v128 offset:0
    ds_read_b64_tr_b16 v[64:65], v127 offset:2816
    ds_read_b64_tr_b16 v[66:67], v127 offset:2848
    ds_read_b64_tr_b16 v[68:69], v127 offset:3072
    ds_read_b64_tr_b16 v[70:71], v127 offset:3104
    ds_read_b64_tr_b16 v[80:81], v128 offset:160
    ds_read_b64_tr_b16 v[82:83], v128 offset:128
    ds_read_b64_tr_b16 v[72:73], v127 offset:3328
    ds_read_b64_tr_b16 v[74:75], v127 offset:3360
    ds_read_b64_tr_b16 v[84:85], v128 offset:288
    ds_read_b64_tr_b16 v[86:87], v128 offset:256
    ds_read_b64_tr_b16 v[88:89], v128 offset:416
    ds_read_b64_tr_b16 v[90:91], v128 offset:384
    ds_read_b64_tr_b16 v[92:93], v128 offset:544
    ds_read_b64_tr_b16 v[94:95], v128 offset:512
    s_waitcnt lgkmcnt(14)
    ds_read_b64_tr_b16 v[60:61], v127 offset:2560
    ds_read_b64_tr_b16 v[62:63], v127 offset:2592
    s_waitcnt lgkmcnt(14)
    v_mfma_f32_16x16x32_bf16 v[0:3], v[64:67], v[76:79], 0
    ds_read_b64_tr_b16 v[96:97], v128 offset:672
    ds_read_b64_tr_b16 v[98:99], v128 offset:640
    ds_read_b64_tr_b16 v[56:57], v127 offset:2304
    ds_read_b64_tr_b16 v[58:59], v127 offset:2336
    s_waitcnt lgkmcnt(15)
    v_mfma_f32_16x16x32_bf16 v[8:11], v[68:71], v[76:79], 0
    ds_read_b64_tr_b16 v[52:53], v127 offset:2048
    ds_read_b64_tr_b16 v[54:55], v127 offset:2080
    s_waitcnt lgkmcnt(14)
    v_mfma_f32_16x16x32_bf16 v[16:19], v[72:75], v[76:79], 0
    s_waitcnt lgkmcnt(15)
    ds_read_b64_tr_b16 v[48:49], v127 offset:1792
    ds_read_b64_tr_b16 v[50:51], v127 offset:1824
    v_mfma_f32_16x16x32_bf16 v[4:7], v[64:67], v[80:83], 0
    ds_read_b64_tr_b16 v[76:77], v128 offset:800
    ds_read_b64_tr_b16 v[78:79], v128 offset:768
    ds_read_b64_tr_b16 a[0:1], v123 offset:32768
    ds_read_b64_tr_b16 a[2:3], v123 offset:34816
    ds_read_b64_tr_b16 a[4:5], v123 offset:32776
    ds_read_b64_tr_b16 a[6:7], v123 offset:34824
    ds_read_b64_tr_b16 a[8:9], v124 offset:32768
    ds_read_b64_tr_b16 a[10:11], v124 offset:34816
    ds_read_b64_tr_b16 a[12:13], v124 offset:32776
    ds_read_b64_tr_b16 a[14:15], v124 offset:34824
    ds_read_b64_tr_b16 v[44:45], v127 offset:1536
    ds_read_b64_tr_b16 v[46:47], v127 offset:1568
    v_mfma_f32_16x16x32_bf16 v[12:15], v[68:71], v[80:83], 0
    s_waitcnt lgkmcnt(15)
    ds_read_b64_tr_b16 v[40:41], v127 offset:1280
    ds_read_b64_tr_b16 v[42:43], v127 offset:1312
    s_waitcnt lgkmcnt(15)
    v_mfma_f32_16x16x32_bf16 v[0:3], v[60:63], v[84:87], v[0:3]
    ds_read_b64_tr_b16 v[80:81], v128 offset:928
    ds_read_b64_tr_b16 v[82:83], v128 offset:896
    ds_read_b64_tr_b16 v[36:37], v127 offset:1024
    ds_read_b64_tr_b16 v[38:39], v127 offset:1056
    v_mfma_f32_16x16x32_bf16 v[8:11], v[64:67], v[84:87], v[8:11]
    ds_read_b64_tr_b16 v[32:33], v127 offset:768
    ds_read_b64_tr_b16 v[34:35], v127 offset:800
    v_mfma_f32_16x16x32_bf16 v[16:19], v[68:71], v[84:87], v[16:19]
    ds_read_b64_tr_b16 a[16:17], v121 offset:0
    ds_read_b64_tr_b16 a[18:19], v121 offset:2048
    ds_read_b64_tr_b16 a[20:21], v121 offset:8
    ds_read_b64_tr_b16 a[22:23], v121 offset:2056
    ds_read_b64_tr_b16 a[24:25], v122 offset:0
    ds_read_b64_tr_b16 a[26:27], v122 offset:2048
    ds_read_b64_tr_b16 a[28:29], v122 offset:8
    ds_read_b64_tr_b16 a[30:31], v122 offset:2056
    s_waitcnt lgkmcnt(15)
    ds_read_b64_tr_b16 v[28:29], v127 offset:512
    ds_read_b64_tr_b16 v[30:31], v127 offset:544
    v_mfma_f32_16x16x32_bf16 v[4:7], v[60:63], v[88:91], v[4:7]
    ds_read_b64_tr_b16 v[84:85], v128 offset:1056
    ds_read_b64_tr_b16 v[86:87], v128 offset:1024
    ds_read_b64_tr_b16 v[24:25], v127 offset:256
    ds_read_b64_tr_b16 v[26:27], v127 offset:288
    v_mfma_f32_16x16x32_bf16 v[12:15], v[64:67], v[88:91], v[12:15]
    s_waitcnt lgkmcnt(15)
    ds_read_b64_tr_b16 v[20:21], v127 offset:0
    ds_read_b64_tr_b16 v[22:23], v127 offset:32
    s_waitcnt lgkmcnt(15)
    v_mfma_f32_16x16x32_bf16 v[0:3], v[56:59], v[92:95], v[0:3]
    ds_read_b64_tr_b16 v[88:89], v128 offset:1184
    ds_read_b64_tr_b16 v[90:91], v128 offset:1152
    v_mfma_f32_16x16x32_bf16 v[8:11], v[60:63], v[92:95], v[8:11]
    ds_read_b64_tr_b16 a[32:33], v121 offset:32768
    ds_read_b64_tr_b16 a[34:35], v121 offset:34816
    ds_read_b64_tr_b16 a[36:37], v121 offset:32776
    ds_read_b64_tr_b16 a[38:39], v121 offset:34824
    ds_read_b64_tr_b16 a[40:41], v122 offset:32768
    ds_read_b64_tr_b16 a[42:43], v122 offset:34816
    ds_read_b64_tr_b16 a[44:45], v122 offset:32776
    ds_read_b64_tr_b16 a[46:47], v122 offset:34824
    v_mfma_f32_16x16x32_bf16 v[16:19], v[64:67], v[92:95], v[16:19]
    s_waitcnt lgkmcnt(15)
    v_mfma_f32_16x16x32_bf16 v[4:7], v[56:59], v[96:99], v[4:7]
    ds_read_b64_tr_b16 v[92:93], v128 offset:1312
    ds_read_b64_tr_b16 v[94:95], v128 offset:1280
    v_mfma_f32_16x16x32_bf16 v[12:15], v[60:63], v[96:99], v[12:15]
    s_waitcnt lgkmcnt(15)
    s_waitcnt lgkmcnt(15)
    v_mfma_f32_16x16x32_bf16 v[0:3], v[52:55], v[76:79], v[0:3]
    ds_read_b64_tr_b16 v[96:97], v128 offset:1440
    ds_read_b64_tr_b16 v[98:99], v128 offset:1408
    s_mul_i32 s50, s43, 7
    s_add_u32 s50, s50, s100
    s_mul_i32 s50, s50, 28672
    s_add_u32 s100, s100, 1
    s_cmp_eq_u32 s100, 7
    s_cselect_b32 s100, 0, s100
    s_waitcnt lgkmcnt(15)
    s_add_u32 m0, s48, 98304
    s_nop 0
    buffer_load_dwordx4 v120, s[24:27], s50 offen lds
    v_mfma_f32_16x16x32_bf16 v[8:11], v[56:59], v[76:79], v[8:11]
    v_mfma_f32_16x16x32_bf16 v[16:19], v[60:63], v[76:79], v[16:19]
    s_add_u32 s50, s50, 7168
    s_add_u32 m0, s48, 99328
    s_nop 0
    buffer_load_dwordx4 v120, s[24:27], s50 offen lds
    s_waitcnt lgkmcnt(15)
    v_mfma_f32_16x16x32_bf16 v[4:7], v[52:55], v[80:83], v[4:7]
    ds_read_b64_tr_b16 v[76:77], v128 offset:1568
    ds_read_b64_tr_b16 v[78:79], v128 offset:1536
    v_mfma_f32_16x16x32_bf16 v[12:15], v[56:59], v[80:83], v[12:15]
    s_add_u32 s50, s50, 7168
    s_add_u32 m0, s48, 100352
    s_nop 0
    buffer_load_dwordx4 v120, s[24:27], s50 offen lds
    s_waitcnt lgkmcnt(15)
    s_waitcnt lgkmcnt(15)
    v_mfma_f32_16x16x32_bf16 v[0:3], v[48:51], v[84:87], v[0:3]
    ds_read_b64_tr_b16 v[80:81], v128 offset:1696
    ds_read_b64_tr_b16 v[82:83], v128 offset:1664
    v_mfma_f32_16x16x32_bf16 v[8:11], v[52:55], v[84:87], v[8:11]
    s_add_u32 s50, s50, 7168
    s_add_u32 m0, s48, 101376
    s_nop 0
    buffer_load_dwordx4 v120, s[24:27], s50 offen lds
    v_mfma_f32_16x16x32_bf16 v[16:19], v[56:59], v[84:87], v[16:19]
    s_waitcnt lgkmcnt(15)
    v_mfma_f32_16x16x32_bf16 v[4:7], v[48:51], v[88:91], v[4:7]
    ds_read_b64_tr_b16 v[84:85], v128 offset:1824
    ds_read_b64_tr_b16 v[86:87], v128 offset:1792
    s_mul_i32 s50, s43, 7
    s_add_u32 s50, s50, s100
    s_mul_i32 s50, s50, 28672
    s_add_u32 s100, s100, 1
    s_cmp_eq_u32 s100, 7
    s_cselect_b32 s100, 0, s100
    s_waitcnt lgkmcnt(15)
    s_add_u32 m0, s48, 0
    s_nop 0
    buffer_load_dwordx4 v120, s[24:27], s50 offen lds
    v_mfma_f32_16x16x32_bf16 v[12:15], v[52:55], v[88:91], v[12:15]
    s_waitcnt lgkmcnt(8)
    s_waitcnt lgkmcnt(15)
    v_mfma_f32_16x16x32_bf16 v[0:3], v[44:47], v[92:95], v[0:3]
    ds_read_b64_tr_b16 v[88:89], v128 offset:1952
    ds_read_b64_tr_b16 v[90:91], v128 offset:1920
    s_add_u32 s50, s50, 7168
    s_add_u32 m0, s48, 1024
    s_nop 0
    buffer_load_dwordx4 v120, s[24:27], s50 offen lds
    v_mfma_f32_16x16x32_bf16 v[8:11], v[48:51], v[92:95], v[8:11]
    v_mfma_f32_16x16x32_bf16 v[16:19], v[52:55], v[92:95], v[16:19]
    s_add_u32 s50, s50, 7168
    s_add_u32 m0, s48, 2048
    s_nop 0
    buffer_load_dwordx4 v120, s[24:27], s50 offen lds
    s_waitcnt lgkmcnt(8)
    v_mfma_f32_16x16x32_bf16 v[4:7], v[44:47], v[96:99], v[4:7]
    ds_read_b64_tr_b16 v[92:93], v128 offset:2080
    ds_read_b64_tr_b16 v[94:95], v128 offset:2048
    v_mfma_f32_16x16x32_bf16 v[12:15], v[48:51], v[96:99], v[12:15]
    s_add_u32 s50, s50, 7168
    s_add_u32 m0, s48, 3072
    s_nop 0
    buffer_load_dwordx4 v120, s[24:27], s50 offen lds
    s_waitcnt lgkmcnt(8)
    s_waitcnt lgkmcnt(15)
    v_mfma_f32_16x16x32_bf16 v[0:3], v[40:43], v[76:79], v[0:3]
    ds_read_b64_tr_b16 v[96:97], v128 offset:2208
    ds_read_b64_tr_b16 v[98:99], v128 offset:2176
    v_mfma_f32_16x16x32_bf16 v[8:11], v[44:47], v[76:79], v[8:11]
    s_mul_i32 s50, s43, 7
    s_add_u32 s50, s50, s100
    s_mul_i32 s50, s50, 28672
    s_add_u32 s100, s100, 1
    s_cmp_eq_u32 s100, 7
    s_cselect_b32 s100, 0, s100
    s_waitcnt lgkmcnt(15)
    s_add_u32 m0, s48, 32768
    s_nop 0
    buffer_load_dwordx4 v120, s[24:27], s50 offen lds
    v_mfma_f32_16x16x32_bf16 v[16:19], v[48:51], v[76:79], v[16:19]
    s_waitcnt lgkmcnt(8)
    v_mfma_f32_16x16x32_bf16 v[4:7], v[40:43], v[80:83], v[4:7]
    ds_read_b64_tr_b16 v[76:77], v128 offset:2336
    ds_read_b64_tr_b16 v[78:79], v128 offset:2304
    s_add_u32 s50, s50, 7168
    s_add_u32 m0, s48, 33792
    s_nop 0
    buffer_load_dwordx4 v120, s[24:27], s50 offen lds
    s_cmp_lg_u32 s55, 1
    s_cbranch_scc1 L_m2s_2_34
    s_waitcnt vmcnt(10)
    s_mov_b64 exec, 0x7f
    buffer_store_dwordx2 v[130:131], v115, s[28:31], s58 offen sc1
    s_mov_b64 exec, -1
L_m2s_2_34:
    v_mfma_f32_16x16x32_bf16 v[12:15], v[44:47], v[80:83], v[12:15]
    s_waitcnt lgkmcnt(8)
    s_waitcnt lgkmcnt(15)
    v_mfma_f32_16x16x32_bf16 v[0:3], v[36:39], v[84:87], v[0:3]
    ds_read_b64_tr_b16 v[80:81], v128 offset:2464
    ds_read_b64_tr_b16 v[82:83], v128 offset:2432
    s_add_u32 s50, s50, 7168
    s_add_u32 m0, s48, 34816
    s_nop 0
    buffer_load_dwordx4 v120, s[24:27], s50 offen lds
    v_mfma_f32_16x16x32_bf16 v[8:11], v[40:43], v[84:87], v[8:11]
    v_mfma_f32_16x16x32_bf16 v[16:19], v[44:47], v[84:87], v[16:19]
    s_add_u32 s50, s50, 7168
    s_add_u32 m0, s48, 35840
    s_nop 0
    buffer_load_dwordx4 v120, s[24:27], s50 offen lds
    s_waitcnt lgkmcnt(8)
    v_mfma_f32_16x16x32_bf16 v[4:7], v[36:39], v[88:91], v[4:7]
    ds_read_b64_tr_b16 v[84:85], v128 offset:2592
    ds_read_b64_tr_b16 v[86:87], v128 offset:2560
    v_mfma_f32_16x16x32_bf16 v[12:15], v[40:43], v[88:91], v[12:15]
    s_waitcnt lgkmcnt(8)
    s_waitcnt lgkmcnt(15)
    v_mfma_f32_16x16x32_bf16 v[0:3], v[32:35], v[92:95], v[0:3]
    ds_read_b64_tr_b16 v[88:89], v128 offset:2720
    ds_read_b64_tr_b16 v[90:91], v128 offset:2688
    v_mfma_f32_16x16x32_bf16 v[8:11], v[36:39], v[92:95], v[8:11]
    v_mfma_f32_16x16x32_bf16 v[16:19], v[40:43], v[92:95], v[16:19]
    s_waitcnt lgkmcnt(8)
    v_mfma_f32_16x16x32_bf16 v[4:7], v[32:35], v[96:99], v[4:7]
    ds_read_b64_tr_b16 v[92:93], v128 offset:2848
    ds_read_b64_tr_b16 v[94:95], v128 offset:2816
    v_mfma_f32_16x16x32_bf16 v[12:15], v[36:39], v[96:99], v[12:15]
    s_waitcnt lgkmcnt(8)
    s_waitcnt lgkmcnt(15)
    v_mfma_f32_16x16x32_bf16 v[0:3], v[28:31], v[76:79], v[0:3]
    ds_read_b64_tr_b16 v[96:97], v128 offset:2976
    ds_read_b64_tr_b16 v[98:99], v128 offset:2944
    v_mfma_f32_16x16x32_bf16 v[8:11], v[32:35], v[76:79], v[8:11]
    v_mfma_f32_16x16x32_bf16 v[16:19], v[36:39], v[76:79], v[16:19]
    s_waitcnt lgkmcnt(8)
    v_mfma_f32_16x16x32_bf16 v[4:7], v[28:31], v[80:83], v[4:7]
    ds_read_b64_tr_b16 v[76:77], v128 offset:3104
    ds_read_b64_tr_b16 v[78:79], v128 offset:3072
    v_mfma_f32_16x16x32_bf16 v[12:15], v[32:35], v[80:83], v[12:15]
    s_cmp_lg_u32 s55, 0
    s_cbranch_scc1 L_m2s_2_50
    s_waitcnt vmcnt(12)
    s_mov_b64 exec, 0x7f
    buffer_store_dwordx2 v[130:131], v115, s[28:31], s58 offen sc1
    s_mov_b64 exec, -1
L_m2s_2_50:
    s_waitcnt lgkmcnt(8)
    s_waitcnt lgkmcnt(15)
    v_mfma_f32_16x16x32_bf16 v[0:3], v[24:27], v[84:87], v[0:3]
    ds_read_b64_tr_b16 v[80:81], v128 offset:3232
    ds_read_b64_tr_b16 v[82:83], v128 offset:3200
    v_mfma_f32_16x16x32_bf16 v[8:11], v[28:31], v[84:87], v[8:11]
    v_mfma_f32_16x16x32_bf16 v[16:19], v[32:35], v[84:87], v[16:19]
    s_waitcnt lgkmcnt(8)
    v_mfma_f32_16x16x32_bf16 v[4:7], v[24:27], v[88:91], v[4:7]
    ds_read_b64_tr_b16 v[84:85], v128 offset:3360
    ds_read_b64_tr_b16 v[86:87], v128 offset:3328
    v_mfma_f32_16x16x32_bf16 v[12:15], v[28:31], v[88:91], v[12:15]
    s_waitcnt lgkmcnt(8)
    s_waitcnt lgkmcnt(15)
    v_mfma_f32_16x16x32_bf16 v[0:3], v[20:23], v[92:95], v[0:3]
    v_mfma_f32_16x16x32_bf16 v[8:11], v[24:27], v[92:95], v[8:11]
    v_mfma_f32_16x16x32_bf16 v[16:19], v[28:31], v[92:95], v[16:19]
    s_waitcnt lgkmcnt(6)
    v_mfma_f32_16x16x32_bf16 v[4:7], v[20:23], v[96:99], v[4:7]
    v_mfma_f32_16x16x32_bf16 v[12:15], v[24:27], v[96:99], v[12:15]
    s_nop 2
    v_cndmask_b32 v103, v3, 0, s[46:47]
    s_waitcnt lgkmcnt(4)
    v_mfma_f32_16x16x32_bf16 v[8:11], v[20:23], v[76:79], v[8:11]
    v_mfma_f32_16x16x32_bf16 v[16:19], v[24:27], v[76:79], v[16:19]
    v_add_f32_dpp v2, v103, v2 wave_ror:1 row_mask:0xf bank_mask:0xf
    v_cndmask_b32 v102, v2, 0, s[46:47]
    s_waitcnt lgkmcnt(2)
    v_mfma_f32_16x16x32_bf16 v[12:15], v[20:23], v[80:83], v[12:15]
    s_waitcnt lgkmcnt(0)
    v_mfma_f32_16x16x32_bf16 v[16:19], v[20:23], v[84:87], v[16:19]
    v_add_f32_dpp v1, v102, v1 wave_ror:1 row_mask:0xf bank_mask:0xf
    v_cndmask_b32 v101, v1, 0, s[46:47]
    s_nop 1
    v_add_f32_dpp v0, v101, v0 wave_ror:1 row_mask:0xf bank_mask:0xf
    ds_write_b32 v125, v0 offset:5632
    v_cndmask_b32 v103, v7, v3, s[46:47]
    s_nop 1
    v_add_f32_dpp v6, v103, v6 wave_ror:1 row_mask:0xf bank_mask:0xf
    v_cndmask_b32 v102, v6, v2, s[46:47]
    s_nop 1
    v_add_f32_dpp v5, v102, v5 wave_ror:1 row_mask:0xf bank_mask:0xf
    v_cndmask_b32 v101, v5, v1, s[46:47]
    s_nop 1
    v_add_f32_dpp v4, v101, v4 wave_ror:1 row_mask:0xf bank_mask:0xf
    ds_write_b32 v125, v4 offset:5888
    v_cndmask_b32 v103, v11, v7, s[46:47]
    s_nop 1
    v_add_f32_dpp v10, v103, v10 wave_ror:1 row_mask:0xf bank_mask:0xf
    v_cndmask_b32 v102, v10, v6, s[46:47]
    s_nop 1
    v_add_f32_dpp v9, v102, v9 wave_ror:1 row_mask:0xf bank_mask:0xf
    v_cndmask_b32 v101, v9, v5, s[46:47]
    s_nop 1
    v_add_f32_dpp v8, v101, v8 wave_ror:1 row_mask:0xf bank_mask:0xf
    ds_write_b32 v125, v8 offset:6144
    v_cndmask_b32 v103, v15, v11, s[46:47]
    s_nop 1
    v_add_f32_dpp v14, v103, v14 wave_ror:1 row_mask:0xf bank_mask:0xf
    v_cndmask_b32 v102, v14, v10, s[46:47]
    s_nop 1
    v_add_f32_dpp v13, v102, v13 wave_ror:1 row_mask:0xf bank_mask:0xf
    v_cndmask_b32 v101, v13, v9, s[46:47]
    s_nop 1
    v_add_f32_dpp v12, v101, v12 wave_ror:1 row_mask:0xf bank_mask:0xf
    ds_write_b32 v125, v12 offset:6400
    v_cndmask_b32 v103, v19, v15, s[46:47]
    s_nop 1
    v_add_f32_dpp v18, v103, v18 wave_ror:1 row_mask:0xf bank_mask:0xf
    v_cndmask_b32 v102, v18, v14, s[46:47]
    s_nop 1
    v_add_f32_dpp v17, v102, v17 wave_ror:1 row_mask:0xf bank_mask:0xf
    v_cndmask_b32 v101, v17, v13, s[46:47]
    s_nop 1
    v_add_f32_dpp v16, v101, v16 wave_ror:1 row_mask:0xf bank_mask:0xf
    ds_write_b32 v125, v16 offset:6656
    v_cndmask_b32 v23, 0, v19, s[46:47]
    v_cndmask_b32 v22, 0, v18, s[46:47]
    v_cndmask_b32 v21, 0, v17, s[46:47]
    s_nop 0
    v_add_f32_dpp v22, v23, v22 wave_ror:1 row_mask:0xf bank_mask:0xf
    s_nop 1
    v_add_f32_dpp v21, v22, v21 wave_ror:1 row_mask:0xf bank_mask:0xf
    s_nop 1
    v_mov_b32_dpp v20, v21 wave_ror:1 row_mask:0xf bank_mask:0xf
    s_mul_i32 s92, s55, 768
    s_add_u32 s92, s92, 140288
    v_add_u32 v24, s92, v114
    ds_write_b32 v24, v20
    s_branch L_convJ
L_conv3:
    ds_read_b64_tr_b16 v[84:85], v128 offset:32
    ds_read_b64_tr_b16 v[86:87], v128 offset:0
    ds_read_b64_tr_b16 v[76:77], v127 offset:3584
    ds_read_b64_tr_b16 v[78:79], v127 offset:3616
    ds_read_b64_tr_b16 v[80:81], v127 offset:3840
    ds_read_b64_tr_b16 v[82:83], v127 offset:3872
    ds_read_b64_tr_b16 v[88:89], v128 offset:160
    ds_read_b64_tr_b16 v[90:91], v128 offset:128
    ds_read_b64_tr_b16 v[72:73], v127 offset:3328
    ds_read_b64_tr_b16 v[74:75], v127 offset:3360
    ds_read_b64_tr_b16 v[92:93], v128 offset:288
    ds_read_b64_tr_b16 v[94:95], v128 offset:256
    ds_read_b64_tr_b16 v[96:97], v128 offset:416
    ds_read_b64_tr_b16 v[98:99], v128 offset:384
    ds_read_b64_tr_b16 v[100:101], v128 offset:544
    ds_read_b64_tr_b16 v[102:103], v128 offset:512
    s_waitcnt lgkmcnt(14)
    ds_read_b64_tr_b16 v[68:69], v127 offset:3072
    ds_read_b64_tr_b16 v[70:71], v127 offset:3104
    s_waitcnt lgkmcnt(14)
    v_mfma_f32_16x16x32_bf16 v[4:7], v[76:79], v[84:87], 0
    ds_read_b64_tr_b16 v[104:105], v128 offset:672
    ds_read_b64_tr_b16 v[106:107], v128 offset:640
    ds_read_b64_tr_b16 v[64:65], v127 offset:2816
    ds_read_b64_tr_b16 v[66:67], v127 offset:2848
    s_waitcnt lgkmcnt(15)
    v_mfma_f32_16x16x32_bf16 v[12:15], v[80:83], v[84:87], 0
    s_waitcnt lgkmcnt(14)
    ds_read_b64_tr_b16 v[60:61], v127 offset:2560
    ds_read_b64_tr_b16 v[62:63], v127 offset:2592
    s_waitcnt lgkmcnt(14)
    v_mfma_f32_16x16x32_bf16 v[0:3], v[72:75], v[88:91], 0
    ds_read_b64_tr_b16 v[84:85], v128 offset:800
    ds_read_b64_tr_b16 v[86:87], v128 offset:768
    ds_read_b64_tr_b16 v[56:57], v127 offset:2304
    ds_read_b64_tr_b16 v[58:59], v127 offset:2336
    v_mfma_f32_16x16x32_bf16 v[8:11], v[76:79], v[88:91], 0
    ds_read_b64_tr_b16 a[0:1], v123 offset:32768
    ds_read_b64_tr_b16 a[2:3], v123 offset:34816
    ds_read_b64_tr_b16 a[4:5], v123 offset:32776
    ds_read_b64_tr_b16 a[6:7], v123 offset:34824
    ds_read_b64_tr_b16 a[8:9], v124 offset:32768
    ds_read_b64_tr_b16 a[10:11], v124 offset:34816
    ds_read_b64_tr_b16 a[12:13], v124 offset:32776
    ds_read_b64_tr_b16 a[14:15], v124 offset:34824
    ds_read_b64_tr_b16 v[52:53], v127 offset:2048
    ds_read_b64_tr_b16 v[54:55], v127 offset:2080
    v_mfma_f32_16x16x32_bf16 v[16:19], v[80:83], v[88:91], 0
    s_waitcnt lgkmcnt(15)
    ds_read_b64_tr_b16 v[48:49], v127 offset:1792
    ds_read_b64_tr_b16 v[50:51], v127 offset:1824
    v_mfma_f32_16x16x32_bf16 v[4:7], v[72:75], v[92:95], v[4:7]
    ds_read_b64_tr_b16 v[88:89], v128 offset:928
    ds_read_b64_tr_b16 v[90:91], v128 offset:896
    ds_read_b64_tr_b16 v[44:45], v127 offset:1536
    ds_read_b64_tr_b16 v[46:47], v127 offset:1568
    v_mfma_f32_16x16x32_bf16 v[12:15], v[76:79], v[92:95], v[12:15]
    s_waitcnt lgkmcnt(15)
    ds_read_b64_tr_b16 v[40:41], v127 offset:1280
    ds_read_b64_tr_b16 v[42:43], v127 offset:1312
    s_waitcnt lgkmcnt(15)
    v_mfma_f32_16x16x32_bf16 v[0:3], v[68:71], v[96:99], v[0:3]
    ds_read_b64_tr_b16 v[92:93], v128 offset:1056
    ds_read_b64_tr_b16 v[94:95], v128 offset:1024
    ds_read_b64_tr_b16 a[16:17], v121 offset:0
    ds_read_b64_tr_b16 a[18:19], v121 offset:2048
    ds_read_b64_tr_b16 a[20:21], v121 offset:8
    ds_read_b64_tr_b16 a[22:23], v121 offset:2056
    ds_read_b64_tr_b16 a[24:25], v122 offset:0
    ds_read_b64_tr_b16 a[26:27], v122 offset:2048
    ds_read_b64_tr_b16 a[28:29], v122 offset:8
    ds_read_b64_tr_b16 a[30:31], v122 offset:2056
    ds_read_b64_tr_b16 v[36:37], v127 offset:1024
    ds_read_b64_tr_b16 v[38:39], v127 offset:1056
    v_mfma_f32_16x16x32_bf16 v[8:11], v[72:75], v[96:99], v[8:11]
    ds_read_b64_tr_b16 v[32:33], v127 offset:768
    ds_read_b64_tr_b16 v[34:35], v127 offset:800
    v_mfma_f32_16x16x32_bf16 v[16:19], v[76:79], v[96:99], v[16:19]
    s_waitcnt lgkmcnt(15)
    ds_read_b64_tr_b16 v[28:29], v127 offset:512
    ds_read_b64_tr_b16 v[30:31], v127 offset:544
    v_mfma_f32_16x16x32_bf16 v[4:7], v[68:71], v[100:103], v[4:7]
    ds_read_b64_tr_b16 v[96:97], v128 offset:1184
    ds_read_b64_tr_b16 v[98:99], v128 offset:1152
    ds_read_b64_tr_b16 v[24:25], v127 offset:256
    ds_read_b64_tr_b16 v[26:27], v127 offset:288
    v_mfma_f32_16x16x32_bf16 v[12:15], v[72:75], v[100:103], v[12:15]
    ds_read_b64_tr_b16 a[32:33], v121 offset:32768
    ds_read_b64_tr_b16 a[34:35], v121 offset:34816
    ds_read_b64_tr_b16 a[36:37], v121 offset:32776
    ds_read_b64_tr_b16 a[38:39], v121 offset:34824
    ds_read_b64_tr_b16 a[40:41], v122 offset:32768
    ds_read_b64_tr_b16 a[42:43], v122 offset:34816
    ds_read_b64_tr_b16 a[44:45], v122 offset:32776
    ds_read_b64_tr_b16 a[46:47], v122 offset:34824
    s_waitcnt lgkmcnt(15)
    ds_read_b64_tr_b16 v[20:21], v127 offset:0
    ds_read_b64_tr_b16 v[22:23], v127 offset:32
    s_waitcnt lgkmcnt(15)
    v_mfma_f32_16x16x32_bf16 v[0:3], v[64:67], v[104:107], v[0:3]
    ds_read_b64_tr_b16 v[100:101], v128 offset:1312
    ds_read_b64_tr_b16 v[102:103], v128 offset:1280
    v_mfma_f32_16x16x32_bf16 v[8:11], v[68:71], v[104:107], v[8:11]
    v_mfma_f32_16x16x32_bf16 v[16:19], v[72:75], v[104:107], v[16:19]
    s_waitcnt lgkmcnt(15)
    v_mfma_f32_16x16x32_bf16 v[4:7], v[64:67], v[84:87], v[4:7]
    ds_read_b64_tr_b16 v[104:105], v128 offset:1440
    ds_read_b64_tr_b16 v[106:107], v128 offset:1408
    s_mul_i32 s50, s43, 7
    s_add_u32 s50, s50, s100
    s_mul_i32 s50, s50, 28672
    s_add_u32 s100, s100, 1
    s_cmp_eq_u32 s100, 7
    s_cselect_b32 s100, 0, s100
    s_waitcnt lgkmcnt(15)
    s_add_u32 m0, s48, 98304
    s_nop 0
    buffer_load_dwordx4 v120, s[24:27], s50 offen lds
    v_mfma_f32_16x16x32_bf16 v[12:15], v[68:71], v[84:87], v[12:15]
    s_waitcnt lgkmcnt(15)
    s_waitcnt lgkmcnt(15)
    v_mfma_f32_16x16x32_bf16 v[0:3], v[60:63], v[88:91], v[0:3]
    ds_read_b64_tr_b16 v[84:85], v128 offset:1568
    ds_read_b64_tr_b16 v[86:87], v128 offset:1536
    s_add_u32 s50, s50, 7168
    s_add_u32 m0, s48, 99328
    s_nop 0
    buffer_load_dwordx4 v120, s[24:27], s50 offen lds
    v_mfma_f32_16x16x32_bf16 v[8:11], v[64:67], v[88:91], v[8:11]
    v_mfma_f32_16x16x32_bf16 v[16:19], v[68:71], v[88:91], v[16:19]
    s_add_u32 s50, s50, 7168
    s_add_u32 m0, s48, 100352
    s_nop 0
    buffer_load_dwordx4 v120, s[24:27], s50 offen lds
    s_waitcnt lgkmcnt(15)
    v_mfma_f32_16x16x32_bf16 v[4:7], v[60:63], v[92:95], v[4:7]
    ds_read_b64_tr_b16 v[88:89], v128 offset:1696
    ds_read_b64_tr_b16 v[90:91], v128 offset:1664
    v_mfma_f32_16x16x32_bf16 v[12:15], v[64:67], v[92:95], v[12:15]
    s_add_u32 s50, s50, 7168
    s_add_u32 m0, s48, 101376
    s_nop 0
    buffer_load_dwordx4 v120, s[24:27], s50 offen lds
    s_waitcnt lgkmcnt(15)
    s_waitcnt lgkmcnt(15)
    v_mfma_f32_16x16x32_bf16 v[0:3], v[56:59], v[96:99], v[0:3]
    ds_read_b64_tr_b16 v[92:93], v128 offset:1824
    ds_read_b64_tr_b16 v[94:95], v128 offset:1792
    v_mfma_f32_16x16x32_bf16 v[8:11], v[60:63], v[96:99], v[8:11]
    s_mul_i32 s50, s43, 7
    s_add_u32 s50, s50, s100
    s_mul_i32 s50, s50, 28672
    s_add_u32 s100, s100, 1
    s_cmp_eq_u32 s100, 7
    s_cselect_b32 s100, 0, s100
    s_waitcnt lgkmcnt(15)
    s_add_u32 m0, s48, 0
    s_nop 0
    buffer_load_dwordx4 v120, s[24:27], s50 offen lds
    v_mfma_f32_16x16x32_bf16 v[16:19], v[64:67], v[96:99], v[16:19]
    s_waitcnt lgkmcnt(8)
    v_mfma_f32_16x16x32_bf16 v[4:7], v[56:59], v[100:103], v[4:7]
    ds_read_b64_tr_b16 v[96:97], v128 offset:1952
    ds_read_b64_tr_b16 v[98:99], v128 offset:1920
    s_add_u32 s50, s50, 7168
    s_add_u32 m0, s48, 1024
    s_nop 0
    buffer_load_dwordx4 v120, s[24:27], s50 offen lds
    v_mfma_f32_16x16x32_bf16 v[12:15], v[60:63], v[100:103], v[12:15]
    s_waitcnt lgkmcnt(8)
    s_waitcnt lgkmcnt(15)
    v_mfma_f32_16x16x32_bf16 v[0:3], v[52:55], v[104:107], v[0:3]
    ds_read_b64_tr_b16 v[100:101], v128 offset:2080
    ds_read_b64_tr_b16 v[102:103], v128 offset:2048
    s_add_u32 s50, s50, 7168
    s_add_u32 m0, s48, 2048
    s_nop 0
    buffer_load_dwordx4 v120, s[24:27], s50 offen lds
    v_mfma_f32_16x16x32_bf16 v[8:11], v[56:59], v[104:107], v[8:11]
    v_mfma_f32_16x16x32_bf16 v[16:19], v[60:63], v[104:107], v[16:19]
    s_add_u32 s50, s50, 7168
    s_add_u32 m0, s48, 3072
    s_nop 0
    buffer_load_dwordx4 v120, s[24:27], s50 offen lds
    s_waitcnt lgkmcnt(8)
    v_mfma_f32_16x16x32_bf16 v[4:7], v[52:55], v[84:87], v[4:7]
    ds_read_b64_tr_b16 v[104:105], v128 offset:2208
    ds_read_b64_tr_b16 v[106:107], v128 offset:2176
    v_mfma_f32_16x16x32_bf16 v[12:15], v[56:59], v[84:87], v[12:15]
    s_mul_i32 s50, s43, 7
    s_add_u32 s50, s50, s100
    s_mul_i32 s50, s50, 28672
    s_add_u32 s100, s100, 1
    s_cmp_eq_u32 s100, 7
    s_cselect_b32 s100, 0, s100
    s_waitcnt lgkmcnt(15)
    s_add_u32 m0, s48, 32768
    s_nop 0
    buffer_load_dwordx4 v120, s[24:27], s50 offen lds
    s_waitcnt lgkmcnt(8)
    s_waitcnt lgkmcnt(15)
    v_mfma_f32_16x16x32_bf16 v[0:3], v[48:51], v[88:91], v[0:3]
    ds_read_b64_tr_b16 v[84:85], v128 offset:2336
    ds_read_b64_tr_b16 v[86:87], v128 offset:2304
    v_mfma_f32_16x16x32_bf16 v[8:11], v[52:55], v[88:91], v[8:11]
    s_add_u32 s50, s50, 7168
    s_add_u32 m0, s48, 33792
    s_nop 0
    buffer_load_dwordx4 v120, s[24:27], s50 offen lds
    s_cmp_lg_u32 s55, 1
    s_cbranch_scc1 L_m2s_3_34
    s_waitcnt vmcnt(10)
    s_mov_b64 exec, 0x7f
    buffer_store_dwordx2 v[130:131], v115, s[28:31], s58 offen sc1
    s_mov_b64 exec, -1
L_m2s_3_34:
    v_mfma_f32_16x16x32_bf16 v[16:19], v[56:59], v[88:91], v[16:19]
    s_waitcnt lgkmcnt(8)
    v_mfma_f32_16x16x32_bf16 v[4:7], v[48:51], v[92:95], v[4:7]
    ds_read_b64_tr_b16 v[88:89], v128 offset:2464
    ds_read_b64_tr_b16 v[90:91], v128 offset:2432
    s_add_u32 s50, s50, 7168
    s_add_u32 m0, s48, 34816
    s_nop 0
    buffer_load_dwordx4 v120, s[24:27], s50 offen lds
    v_mfma_f32_16x16x32_bf16 v[12:15], v[52:55], v[92:95], v[12:15]
    s_waitcnt lgkmcnt(8)
    s_waitcnt lgkmcnt(15)
    v_mfma_f32_16x16x32_bf16 v[0:3], v[44:47], v[96:99], v[0:3]
    ds_read_b64_tr_b16 v[92:93], v128 offset:2592
    ds_read_b64_tr_b16 v[94:95], v128 offset:2560
    s_add_u32 s50, s50, 7168
    s_add_u32 m0, s48, 35840
    s_nop 0
    buffer_load_dwordx4 v120, s[24:27], s50 offen lds
    v_mfma_f32_16x16x32_bf16 v[8:11], v[48:51], v[96:99], v[8:11]
    v_mfma_f32_16x16x32_bf16 v[16:19], v[52:55], v[96:99], v[16:19]
    s_waitcnt lgkmcnt(8)
    v_mfma_f32_16x16x32_bf16 v[4:7], v[44:47], v[100:103], v[4:7]
    ds_read_b64_tr_b16 v[96:97], v128 offset:2720
    ds_read_b64_tr_b16 v[98:99], v128 offset:2688
    v_mfma_f32_16x16x32_bf16 v[12:15], v[48:51], v[100:103], v[12:15]
    s_waitcnt lgkmcnt(8)
    s_waitcnt lgkmcnt(15)
    v_mfma_f32_16x16x32_bf16 v[0:3], v[40:43], v[104:107], v[0:3]
    ds_read_b64_tr_b16 v[100:101], v128 offset:2848
    ds_read_b64_tr_b16 v[102:103], v128 offset:2816
    v_mfma_f32_16x16x32_bf16 v[8:11], v[44:47], v[104:107], v[8:11]
    v_mfma_f32_16x16x32_bf16 v[16:19], v[48:51], v[104:107], v[16:19]
    s_waitcnt lgkmcnt(8)
    v_mfma_f32_16x16x32_bf16 v[4:7], v[40:43], v[84:87], v[4:7]
    ds_read_b64_tr_b16 v[104:105], v128 offset:2976
    ds_read_b64_tr_b16 v[106:107], v128 offset:2944
    v_mfma_f32_16x16x32_bf16 v[12:15], v[44:47], v[84:87], v[12:15]
    s_waitcnt lgkmcnt(8)
    s_waitcnt lgkmcnt(15)
    v_mfma_f32_16x16x32_bf16 v[0:3], v[36:39], v[88:91], v[0:3]
    ds_read_b64_tr_b16 v[84:85], v128 offset:3104
    ds_read_b64_tr_b16 v[86:87], v128 offset:3072
    v_mfma_f32_16x16x32_bf16 v[8:11], v[40:43], v[88:91], v[8:11]
    v_mfma_f32_16x16x32_bf16 v[16:19], v[44:47], v[88:91], v[16:19]
    s_cmp_lg_u32 s55, 0
    s_cbranch_scc1 L_m2s_3_50
    s_waitcnt vmcnt(12)
    s_mov_b64 exec, 0x7f
    buffer_store_dwordx2 v[130:131], v115, s[28:31], s58 offen sc1
    s_mov_b64 exec, -1
L_m2s_3_50:
    s_waitcnt lgkmcnt(8)
    v_mfma_f32_16x16x32_bf16 v[4:7], v[36:39], v[92:95], v[4:7]
    ds_read_b64_tr_b16 v[88:89], v128 offset:3232
    ds_read_b64_tr_b16 v[90:91], v128 offset:3200
    v_mfma_f32_16x16x32_bf16 v[12:15], v[40:43], v[92:95], v[12:15]
    s_waitcnt lgkmcnt(8)
    s_waitcnt lgkmcnt(15)
    v_mfma_f32_16x16x32_bf16 v[0:3], v[32:35], v[96:99], v[0:3]
    ds_read_b64_tr_b16 v[92:93], v128 offset:3360
    ds_read_b64_tr_b16 v[94:95], v128 offset:3328
    v_mfma_f32_16x16x32_bf16 v[8:11], v[36:39], v[96:99], v[8:11]
    v_mfma_f32_16x16x32_bf16 v[16:19], v[40:43], v[96:99], v[16:19]
    s_waitcnt lgkmcnt(8)
    v_mfma_f32_16x16x32_bf16 v[4:7], v[32:35], v[100:103], v[4:7]
    ds_read_b64_tr_b16 v[96:97], v128 offset:3488
    ds_read_b64_tr_b16 v[98:99], v128 offset:3456
    v_mfma_f32_16x16x32_bf16 v[12:15], v[36:39], v[100:103], v[12:15]
    s_waitcnt lgkmcnt(8)
    s_waitcnt lgkmcnt(15)
    v_mfma_f32_16x16x32_bf16 v[0:3], v[28:31], v[104:107], v[0:3]
    ds_read_b64_tr_b16 v[100:101], v128 offset:3616
    ds_read_b64_tr_b16 v[102:103], v128 offset:3584
    v_mfma_f32_16x16x32_bf16 v[8:11], v[32:35], v[104:107], v[8:11]
    v_mfma_f32_16x16x32_bf16 v[16:19], v[36:39], v[104:107], v[16:19]
    s_waitcnt lgkmcnt(8)
    v_mfma_f32_16x16x32_bf16 v[4:7], v[28:31], v[84:87], v[4:7]
    ds_read_b64_tr_b16 v[104:105], v128 offset:3744
    ds_read_b64_tr_b16 v[106:107], v128 offset:3712
    v_mfma_f32_16x16x32_bf16 v[12:15], v[32:35], v[84:87], v[12:15]
    s_waitcnt lgkmcnt(8)
    s_waitcnt lgkmcnt(15)
    v_mfma_f32_16x16x32_bf16 v[0:3], v[24:27], v[88:91], v[0:3]
    ds_read_b64_tr_b16 v[84:85], v128 offset:3872
    ds_read_b64_tr_b16 v[86:87], v128 offset:3840
    v_mfma_f32_16x16x32_bf16 v[8:11], v[28:31], v[88:91], v[8:11]
    v_mfma_f32_16x16x32_bf16 v[16:19], v[32:35], v[88:91], v[16:19]
    s_waitcnt lgkmcnt(8)
    v_mfma_f32_16x16x32_bf16 v[4:7], v[24:27], v[92:95], v[4:7]
    ds_read_b64_tr_b16 v[88:89], v128 offset:4000
    ds_read_b64_tr_b16 v[90:91], v128 offset:3968
    v_mfma_f32_16x16x32_bf16 v[12:15], v[28:31], v[92:95], v[12:15]
    s_waitcnt lgkmcnt(8)
    s_waitcnt lgkmcnt(15)
    v_mfma_f32_16x16x32_bf16 v[0:3], v[20:23], v[96:99], v[0:3]
    v_mfma_f32_16x16x32_bf16 v[8:11], v[24:27], v[96:99], v[8:11]
    v_mfma_f32_16x16x32_bf16 v[16:19], v[28:31], v[96:99], v[16:19]
    s_waitcnt lgkmcnt(6)
    v_mfma_f32_16x16x32_bf16 v[4:7], v[20:23], v[100:103], v[4:7]
    v_mfma_f32_16x16x32_bf16 v[12:15], v[24:27], v[100:103], v[12:15]
    s_nop 2
    v_cndmask_b32 v111, v3, 0, s[46:47]
    s_waitcnt lgkmcnt(4)
    v_mfma_f32_16x16x32_bf16 v[8:11], v[20:23], v[104:107], v[8:11]
    v_mfma_f32_16x16x32_bf16 v[16:19], v[24:27], v[104:107], v[16:19]
    v_add_f32_dpp v2, v111, v2 wave_ror:1 row_mask:0xf bank_mask:0xf
    v_cndmask_b32 v110, v2, 0, s[46:47]
    s_waitcnt lgkmcnt(2)
    v_mfma_f32_16x16x32_bf16 v[12:15], v[20:23], v[84:87], v[12:15]
    s_waitcnt lgkmcnt(0)
    v_mfma_f32_16x16x32_bf16 v[16:19], v[20:23], v[88:91], v[16:19]
    v_add_f32_dpp v1, v110, v1 wave_ror:1 row_mask:0xf bank_mask:0xf
    v_cndmask_b32 v109, v1, 0, s[46:47]
    s_nop 1
    v_add_f32_dpp v0, v109, v0 wave_ror:1 row_mask:0xf bank_mask:0xf
    ds_write_b32 v125, v0 offset:6912
    v_cndmask_b32 v111, v7, v3, s[46:47]
    s_nop 1
    v_add_f32_dpp v6, v111, v6 wave_ror:1 row_mask:0xf bank_mask:0xf
    v_cndmask_b32 v110, v6, v2, s[46:47]
    s_nop 1
    v_add_f32_dpp v5, v110, v5 wave_ror:1 row_mask:0xf bank_mask:0xf
    v_cndmask_b32 v109, v5, v1, s[46:47]
    s_nop 1
    v_add_f32_dpp v4, v109, v4 wave_ror:1 row_mask:0xf bank_mask:0xf
    ds_write_b32 v125, v4 offset:7168
    v_cndmask_b32 v111, v11, v7, s[46:47]
    s_nop 1
    v_add_f32_dpp v10, v111, v10 wave_ror:1 row_mask:0xf bank_mask:0xf
    v_cndmask_b32 v110, v10, v6, s[46:47]
    s_nop 1
    v_add_f32_dpp v9, v110, v9 wave_ror:1 row_mask:0xf bank_mask:0xf
    v_cndmask_b32 v109, v9, v5, s[46:47]
    s_nop 1
    v_add_f32_dpp v8, v109, v8 wave_ror:1 row_mask:0xf bank_mask:0xf
    ds_write_b32 v125, v8 offset:7424
    v_cndmask_b32 v111, v15, v11, s[46:47]
    s_nop 1
    v_add_f32_dpp v14, v111, v14 wave_ror:1 row_mask:0xf bank_mask:0xf
    v_cndmask_b32 v110, v14, v10, s[46:47]
    s_nop 1
    v_add_f32_dpp v13, v110, v13 wave_ror:1 row_mask:0xf bank_mask:0xf
    v_cndmask_b32 v109, v13, v9, s[46:47]
    s_nop 1
    v_add_f32_dpp v12, v109, v12 wave_ror:1 row_mask:0xf bank_mask:0xf
    ds_write_b32 v125, v12 offset:7680
    v_cndmask_b32 v111, v19, v15, s[46:47]
    s_nop 1
    v_add_f32_dpp v18, v111, v18 wave_ror:1 row_mask:0xf bank_mask:0xf
    v_cndmask_b32 v110, v18, v14, s[46:47]
    s_nop 1
    v_add_f32_dpp v17, v110, v17 wave_ror:1 row_mask:0xf bank_mask:0xf
    v_cndmask_b32 v109, v17, v13, s[46:47]
    s_nop 1
    v_add_f32_dpp v16, v109, v16 wave_ror:1 row_mask:0xf bank_mask:0xf
    ds_write_b32 v125, v16 offset:7936
L_convJ:
    s_nop 4
    s_nop 2
    v_lshlrev_b32 v4, 1, v113
    v_add_u32 v4, 65536, v4
    v_mov_b32 v6, 141312
    v_and_b32 v5, 0xff0, v113
    s_mul_i32 s92, s55, 768
    s_add_u32 s92, s92, 139776
    s_waitcnt vmcnt(8)
    ds_read_b64_tr_b16 a[48:49], v123 offset:32768
    ds_read_b64_tr_b16 a[50:51], v123 offset:34816
    ds_read_b64_tr_b16 a[52:53], v123 offset:32776
    ds_read_b64_tr_b16 a[54:55], v123 offset:34824
    ds_read_b64_tr_b16 a[56:57], v124 offset:32768
    ds_read_b64_tr_b16 a[58:59], v124 offset:34816
    ds_read_b64_tr_b16 a[60:61], v124 offset:32776
    ds_read_b64_tr_b16 a[62:63], v124 offset:34824
    s_waitcnt lgkmcnt(0)
    s_mul_i32 s50, s43, 7
    s_add_u32 s50, s50, s100
    s_mul_i32 s50, s50, 28672
    s_add_u32 s100, s100, 1
    s_cmp_eq_u32 s100, 7
    s_cselect_b32 s100, 0, s100
    s_waitcnt lgkmcnt(0)
    s_add_u32 m0, s48, 98304
    s_nop 0
    buffer_load_dwordx4 v120, s[24:27], s50 offen lds
    s_add_u32 s50, s50, 7168
    s_add_u32 m0, s48, 99328
    s_nop 0
    buffer_load_dwordx4 v120, s[24:27], s50 offen lds
    s_add_u32 s50, s50, 7168
    s_add_u32 m0, s48, 100352
    s_nop 0
    buffer_load_dwordx4 v120, s[24:27], s50 offen lds
    s_add_u32 s50, s50, 7168
    s_add_u32 m0, s48, 101376
    s_nop 0
    buffer_load_dwordx4 v120, s[24:27], s50 offen lds
    s_barrier
    buffer_load_dwordx2 v[116:117], v118, s[28:31], s59 offen offset:512 sc1
    ds_read_b128 v[8:11], v4
    ds_read_b128 v[12:15], v4 offset:16
    s_lshl_b32 s93, s55, 8
    s_add_u32 s93, s93, 131328
    v_add_u32 v7, s93, v113
    ds_read_b128 v[20:23], v7
    v_mov_b32 v7, s92
    v_cmp_eq_u32 vcc, 1920, v5
    s_nop 1
    v_cndmask_b32 v6, v6, v7, vcc
    s_add_u32 s92, s92, 256
    v_mov_b32 v7, s92
    v_cmp_eq_u32 vcc, 2816, v5
    s_nop 1
    v_cndmask_b32 v6, v6, v7, vcc
    s_add_u32 s92, s92, 256
    v_mov_b32 v7, s92
    v_cmp_eq_u32 vcc, 3456, v5
    s_nop 1
    v_cndmask_b32 v6, v6, v7, vcc
    ds_read_b128 v[16:19], v6
    s_lshl_b32 s92, s51, 16
    s_and_b32 s93, s51, 0xffff0000
    s_cmp_eq_u32 s55, 0
    s_cselect_b32 s52, s92, s93
    s_lshl_b32 s96, s40, 13
    s_add_u32 s96, s96, 9175040
    s_waitcnt lgkmcnt(1)
    v_lshlrev_b32 v24, 16, v20
    v_and_b32 v25, 0xffff0000, v20
    v_lshlrev_b32 v26, 16, v21
    v_and_b32 v27, 0xffff0000, v21
    v_lshlrev_b32 v28, 16, v22
    v_and_b32 v29, 0xffff0000, v22
    v_lshlrev_b32 v30, 16, v23
    v_and_b32 v31, 0xffff0000, v23
    v_fmac_f32 v8, s52, v24
    v_fmac_f32 v9, s52, v25
    v_fmac_f32 v10, s52, v26
    v_fmac_f32 v11, s52, v27
    v_fmac_f32 v12, s52, v28
    v_fmac_f32 v13, s52, v29
    v_fmac_f32 v14, s52, v30
    v_fmac_f32 v15, s52, v31
    s_waitcnt lgkmcnt(0)
    v_pk_add_f32 v[8:9], v[8:9], v[16:17]
    v_pk_add_f32 v[10:11], v[10:11], v[18:19]
    v_cvt_pk_bf16_f32 v108, v8, v9
    v_cvt_pk_bf16_f32 v109, v10, v11
    v_cvt_pk_bf16_f32 v110, v12, v13
    v_cvt_pk_bf16_f32 v111, v14, v15
    v_min_u32 v108, -2, v108
    v_min_u32 v109, -2, v109
    v_min_u32 v110, -2, v110
    v_min_u32 v111, -2, v111
    buffer_store_dwordx4 v[108:111], v113, s[28:31], s96 offen sc1
    s_waitcnt vmcnt(1)
    s_mov_b32 s97, 0
L_chk_m2:
    v_xor_b32 v130, s98, v116
    v_xor_b32 v131, s101, v117
    v_or_b32 v130, v130, v131
    v_cmp_ne_u32 vcc, 0, v130
    s_add_u32 s97, s97, 1
    s_nop 3
    s_cbranch_vccz L_ok_m2
    s_cmp_gt_u32 s97, 20000
    s_cbranch_scc1 L_ok_m2
    s_sleep 6
    buffer_load_dwordx2 v[116:117], v118, s[28:31], s59 offen offset:512 sc1
    s_waitcnt vmcnt(0)
    s_branch L_chk_m2
L_ok_m2:
    s_setprio 3
    s_add_u32 s62, s61, 1
    s_and_b32 s62, s62, 3
    s_mul_i32 s62, s62, 56
    s_add_u32 s62, s62, s54
    s_lshl_b32 s62, s62, 10
    s_add_u32 s63, s62, 7168
    s_lshl_b32 s99, s49, 10
    s_add_u32 s99, s99, s62
    buffer_load_dwordx4 v[48:51], v133, s[28:31], s99 offen sc1
    s_add_u32 s99, s99, 1024
    s_cmp_eq_u32 s99, s63
    s_cselect_b32 s99, s62, s99
    buffer_load_dwordx4 v[52:55], v133, s[28:31], s99 offen sc1
    s_add_u32 s99, s99, 1024
    s_cmp_eq_u32 s99, s63
    s_cselect_b32 s99, s62, s99
    buffer_load_dwordx4 v[56:59], v133, s[28:31], s99 offen sc1
    s_add_u32 s99, s99, 1024
    s_cmp_eq_u32 s99, s63
    s_cselect_b32 s99, s62, s99
    buffer_load_dwordx4 v[60:63], v133, s[28:31], s99 offen sc1
    s_add_u32 s99, s99, 1024
    s_cmp_eq_u32 s99, s63
    s_cselect_b32 s99, s62, s99
    buffer_load_dwordx4 v[64:67], v133, s[28:31], s99 offen sc1
    s_add_u32 s99, s99, 1024
    s_cmp_eq_u32 s99, s63
    s_cselect_b32 s99, s62, s99
    ds_read_b64_tr_b16 a[64:65], v121 offset:0
    ds_read_b64_tr_b16 a[66:67], v121 offset:2048
    ds_read_b64_tr_b16 a[68:69], v121 offset:8
    ds_read_b64_tr_b16 a[70:71], v121 offset:2056
    ds_read_b64_tr_b16 a[72:73], v122 offset:0
    ds_read_b64_tr_b16 a[74:75], v122 offset:2048
    ds_read_b64_tr_b16 a[76:77], v122 offset:8
    ds_read_b64_tr_b16 a[78:79], v122 offset:2056
    ds_read_b64_tr_b16 a[80:81], v121 offset:32768
    ds_read_b64_tr_b16 a[82:83], v121 offset:34816
    ds_read_b64_tr_b16 a[84:85], v121 offset:32776
    ds_read_b64_tr_b16 a[86:87], v121 offset:34824
    ds_read_b64_tr_b16 a[88:89], v122 offset:32768
    ds_read_b64_tr_b16 a[90:91], v122 offset:34816
    ds_read_b64_tr_b16 a[92:93], v122 offset:32776
    ds_read_b64_tr_b16 a[94:95], v122 offset:34824
    v_lshrrev_b32 v5, 4, v112
    v_lshlrev_b32 v5, 4, v5
    s_lshl_b32 s92, s38, 7
    s_lshl_b32 s93, s55, 6
    s_add_u32 s92, s92, s93
    v_add_u32 v5, s92, v5
    global_load_dwordx4 v[104:107], v5, s[84:85]
    v_add_u32 v127, s48, v133
    s_add_u32 s92, s56, 1
    s_and_b32 s92, s92, 3
    s_lshl_b32 s93, s55, 2
    s_add_u32 s92, s92, s93
    s_lshl_b32 s92, s92, 12
    v_add_u32 v128, s92, v133
    v_lshrrev_b32 v4, 7, v113
    v_and_b32 v5, 0x70, v113
    v_lshl_add_u32 v125, v4, 12, v5
    v_lshrrev_b32 v4, 4, v112
    v_bfe_u32 v5, v112, 2, 2
    v_and_b32 v6, 3, v112
    v_lshl_add_u32 v4, v4, 3, v5
    v_lshlrev_b32 v4, 7, v4
    v_lshl_add_u32 v4, v6, 3, v4
    s_lshl_b32 s92, s61, 5
    s_lshl_b32 s93, s55, 12
    s_add_u32 s92, s92, s93
    s_add_u32 s92, s92, 141568
    v_add_u32 v132, s92, v4
    v_rcp_f32 v136, v135
    s_lshl_b32 s96, s38, 18
    s_lshl_b32 s93, s39, 7
    v_mul_f32 v137, v136, v136
    s_add_u32 s96, s96, s93
    s_add_u32 s96, s96, 9175040
    v_add_u32 v116, 141568, v113
    s_waitcnt lgkmcnt(0)
    s_setprio 2
    s_waitcnt vmcnt(5)
    v_mfma_f32_16x16x32_bf16 v[0:3], a[0:3], v[48:51], 0
    v_mfma_f32_16x16x32_bf16 v[4:7], a[4:7], v[48:51], 0
    buffer_load_dwordx4 v[68:71], v133, s[28:31], s99 offen sc1
    s_add_u32 s99, s99, 1024
    s_cmp_eq_u32 s99, s63
    s_cselect_b32 s99, s62, s99
    v_mfma_f32_16x16x32_bf16 v[8:11], a[8:11], v[48:51], 0
    v_mfma_f32_16x16x32_bf16 v[12:15], a[12:15], v[48:51], 0
    s_waitcnt vmcnt(5)
    v_mfma_f32_16x16x32_bf16 v[0:3], a[16:19], v[52:55], v[0:3]
    v_mfma_f32_16x16x32_bf16 v[4:7], a[20:23], v[52:55], v[4:7]
    buffer_load_dwordx4 v[72:75], v133, s[28:31], s99 offen sc1
    v_mfma_f32_16x16x32_bf16 v[8:11], a[24:27], v[52:55], v[8:11]
    v_mfma_f32_16x16x32_bf16 v[12:15], a[28:31], v[52:55], v[12:15]
    s_waitcnt vmcnt(5)
    v_mfma_f32_16x16x32_bf16 v[0:3], a[32:35], v[56:59], v[0:3]
    v_mfma_f32_16x16x32_bf16 v[4:7], a[36:39], v[56:59], v[4:7]
    s_add_u32 s62, s61, 2
    s_and_b32 s62, s62, 3
    s_mul_i32 s62, s62, 56
    s_add_u32 s62, s62, s54
    s_lshl_b32 s62, s62, 10
    s_add_u32 s63, s62, 7168
    s_lshl_b32 s99, s49, 10
    s_add_u32 s99, s99, s62
    buffer_load_dwordx4 v[76:79], v133, s[28:31], s99 offen sc1
    s_add_u32 s99, s99, 1024
    s_cmp_eq_u32 s99, s63
    s_cselect_b32 s99, s62, s99
    v_mfma_f32_16x16x32_bf16 v[8:11], a[40:43], v[56:59], v[8:11]
    v_mfma_f32_16x16x32_bf16 v[12:15], a[44:47], v[56:59], v[12:15]
    s_setprio 1
    s_waitcnt vmcnt(5)
    v_mfma_f32_16x16x32_bf16 v[0:3], a[48:51], v[60:63], v[0:3]
    v_mfma_f32_16x16x32_bf16 v[4:7], a[52:55], v[60:63], v[4:7]
    buffer_load_dwordx4 v[80:83], v133, s[28:31], s99 offen sc1
    s_add_u32 s99, s99, 1024
    s_cmp_eq_u32 s99, s63
    s_cselect_b32 s99, s62, s99
    v_mfma_f32_16x16x32_bf16 v[8:11], a[56:59], v[60:63], v[8:11]
    v_mfma_f32_16x16x32_bf16 v[12:15], a[60:63], v[60:63], v[12:15]
    s_waitcnt vmcnt(5)
    ds_read_b64_tr_b16 a[96:97], v123 offset:32768
    ds_read_b64_tr_b16 a[98:99], v123 offset:34816
    ds_read_b64_tr_b16 a[100:101], v123 offset:32776
    ds_read_b64_tr_b16 a[102:103], v123 offset:34824
    ds_read_b64_tr_b16 a[104:105], v124 offset:32768
    ds_read_b64_tr_b16 a[106:107], v124 offset:34816
    ds_read_b64_tr_b16 a[108:109], v124 offset:32776
    ds_read_b64_tr_b16 a[110:111], v124 offset:34824
    v_mfma_f32_16x16x32_bf16 v[0:3], a[64:67], v[64:67], v[0:3]
    v_mfma_f32_16x16x32_bf16 v[4:7], a[68:71], v[64:67], v[4:7]
    buffer_load_dwordx4 v[84:87], v133, s[28:31], s99 offen sc1
    s_add_u32 s99, s99, 1024
    s_cmp_eq_u32 s99, s63
    s_cselect_b32 s99, s62, s99
    v_mfma_f32_16x16x32_bf16 v[8:11], a[72:75], v[64:67], v[8:11]
    v_mfma_f32_16x16x32_bf16 v[12:15], a[76:79], v[64:67], v[12:15]
    s_waitcnt vmcnt(4)
    v_mfma_f32_16x16x32_bf16 v[0:3], a[80:83], v[68:71], v[0:3]
    v_mfma_f32_16x16x32_bf16 v[4:7], a[84:87], v[68:71], v[4:7]
    buffer_load_dwordx4 v[88:91], v133, s[28:31], s99 offen sc1
    s_add_u32 s99, s99, 1024
    s_cmp_eq_u32 s99, s63
    s_cselect_b32 s99, s62, s99
    v_mfma_f32_16x16x32_bf16 v[8:11], a[88:91], v[68:71], v[8:11]
    v_mfma_f32_16x16x32_bf16 v[12:15], a[92:95], v[68:71], v[12:15]
    s_setprio 0
    s_waitcnt vmcnt(4)
    s_waitcnt lgkmcnt(0)
    v_mfma_f32_16x16x32_bf16 v[0:3], a[96:99], v[72:75], v[0:3]
    v_mfma_f32_16x16x32_bf16 v[4:7], a[100:103], v[72:75], v[4:7]
    buffer_load_dwordx4 v[92:95], v133, s[28:31], s99 offen sc1
    s_add_u32 s99, s99, 1024
    s_cmp_eq_u32 s99, s63
    s_cselect_b32 s99, s62, s99
    v_mfma_f32_16x16x32_bf16 v[8:11], a[104:107], v[72:75], v[8:11]
    v_mfma_f32_16x16x32_bf16 v[12:15], a[108:111], v[72:75], v[12:15]
    s_waitcnt vmcnt(4)
    v_mfma_f32_16x16x32_bf16 v[16:19], a[0:3], v[76:79], 0
    v_mfma_f32_16x16x32_bf16 v[20:23], a[4:7], v[76:79], 0
    buffer_load_dwordx4 v[96:99], v133, s[28:31], s99 offen sc1
    s_add_u32 s99, s99, 1024
    s_cmp_eq_u32 s99, s63
    s_cselect_b32 s99, s62, s99
    v_mfma_f32_16x16x32_bf16 v[24:27], a[8:11], v[76:79], 0
    v_mfma_f32_16x16x32_bf16 v[28:31], a[12:15], v[76:79], 0
    s_waitcnt vmcnt(4)
    v_mfma_f32_16x16x32_bf16 v[16:19], a[16:19], v[80:83], v[16:19]
    v_mfma_f32_16x16x32_bf16 v[20:23], a[20:23], v[80:83], v[20:23]
    buffer_load_dwordx4 v[100:103], v133, s[28:31], s99 offen sc1
    v_mfma_f32_16x16x32_bf16 v[24:27], a[24:27], v[80:83], v[24:27]
    v_mfma_f32_16x16x32_bf16 v[28:31], a[28:31], v[80:83], v[28:31]
    ds_write_b128 v127, v[0:3] offset:0
    ds_write_b128 v127, v[4:7] offset:1024
    ds_write_b128 v127, v[8:11] offset:2048
    ds_write_b128 v127, v[12:15] offset:3072
    s_waitcnt vmcnt(4)
    v_mfma_f32_16x16x32_bf16 v[16:19], a[32:35], v[84:87], v[16:19]
    v_mfma_f32_16x16x32_bf16 v[20:23], a[36:39], v[84:87], v[20:23]
    s_add_u32 s62, s61, 3
    s_and_b32 s62, s62, 3
    s_mul_i32 s62, s62, 56
    s_add_u32 s62, s62, s54
    s_lshl_b32 s62, s62, 10
    s_add_u32 s63, s62, 7168
    s_lshl_b32 s99, s49, 10
    s_add_u32 s99, s99, s62
    buffer_load_dwordx4 v[48:51], v133, s[28:31], s99 offen sc1
    s_add_u32 s99, s99, 1024
    s_cmp_eq_u32 s99, s63
    s_cselect_b32 s99, s62, s99
    v_mfma_f32_16x16x32_bf16 v[24:27], a[40:43], v[84:87], v[24:27]
    v_mfma_f32_16x16x32_bf16 v[28:31], a[44:47], v[84:87], v[28:31]
    s_waitcnt vmcnt(4)
    v_mfma_f32_16x16x32_bf16 v[16:19], a[48:51], v[88:91], v[16:19]
    v_mfma_f32_16x16x32_bf16 v[20:23], a[52:55], v[88:91], v[20:23]
    buffer_load_dwordx4 v[52:55], v133, s[28:31], s99 offen sc1
    s_add_u32 s99, s99, 1024
    s_cmp_eq_u32 s99, s63
    s_cselect_b32 s99, s62, s99
    v_mfma_f32_16x16x32_bf16 v[24:27], a[56:59], v[88:91], v[24:27]
    v_mfma_f32_16x16x32_bf16 v[28:31], a[60:63], v[88:91], v[28:31]
    s_waitcnt vmcnt(4)
    v_mfma_f32_16x16x32_bf16 v[16:19], a[64:67], v[92:95], v[16:19]
    v_mfma_f32_16x16x32_bf16 v[20:23], a[68:71], v[92:95], v[20:23]
    buffer_load_dwordx4 v[56:59], v133, s[28:31], s99 offen sc1
    s_add_u32 s99, s99, 1024
    s_cmp_eq_u32 s99, s63
    s_cselect_b32 s99, s62, s99
    v_mfma_f32_16x16x32_bf16 v[24:27], a[72:75], v[92:95], v[24:27]
    v_mfma_f32_16x16x32_bf16 v[28:31], a[76:79], v[92:95], v[28:31]
    s_waitcnt lgkmcnt(0)
    s_barrier
    ds_read_b128 v[40:43], v128 offset:2048
    ds_read_b128 v[44:47], v128 offset:3072
    ds_read_b128 v[32:35], v128 offset:0
    ds_read_b128 v[36:39], v128 offset:1024
    s_waitcnt vmcnt(4)
    v_mfma_f32_16x16x32_bf16 v[16:19], a[80:83], v[96:99], v[16:19]
    v_mfma_f32_16x16x32_bf16 v[20:23], a[84:87], v[96:99], v[20:23]
    buffer_load_dwordx4 v[60:63], v133, s[28:31], s99 offen sc1
    s_add_u32 s99, s99, 1024
    s_cmp_eq_u32 s99, s63
    s_cselect_b32 s99, s62, s99
    v_mfma_f32_16x16x32_bf16 v[24:27], a[88:91], v[96:99], v[24:27]
    v_mfma_f32_16x16x32_bf16 v[28:31], a[92:95], v[96:99], v[28:31]
    s_waitcnt vmcnt(4)
    v_mfma_f32_16x16x32_bf16 v[16:19], a[96:99], v[100:103], v[16:19]
    v_mfma_f32_16x16x32_bf16 v[20:23], a[100:103], v[100:103], v[20:23]
    buffer_load_dwordx4 v[64:67], v133, s[28:31], s99 offen sc1
    s_add_u32 s99, s99, 1024
    s_cmp_eq_u32 s99, s63
    s_cselect_b32 s99, s62, s99
    v_mfma_f32_16x16x32_bf16 v[24:27], a[104:107], v[100:103], v[24:27]
    v_mfma_f32_16x16x32_bf16 v[28:31], a[108:111], v[100:103], v[28:31]
    s_waitcnt vmcnt(4)
    v_mfma_f32_16x16x32_bf16 v[0:3], a[0:3], v[48:51], 0
    v_mfma_f32_16x16x32_bf16 v[4:7], a[4:7], v[48:51], 0
    buffer_load_dwordx4 v[68:71], v133, s[28:31], s99 offen sc1
    s_add_u32 s99, s99, 1024
    s_cmp_eq_u32 s99, s63
    s_cselect_b32 s99, s62, s99
    v_mfma_f32_16x16x32_bf16 v[8:11], a[8:11], v[48:51], 0
    v_mfma_f32_16x16x32_bf16 v[12:15], a[12:15], v[48:51], 0
    s_waitcnt vmcnt(4)
    v_mfma_f32_16x16x32_bf16 v[0:3], a[16:19], v[52:55], v[0:3]
    v_mfma_f32_16x16x32_bf16 v[4:7], a[20:23], v[52:55], v[4:7]
    buffer_load_dwordx4 v[72:75], v133, s[28:31], s99 offen sc1
    v_mfma_f32_16x16x32_bf16 v[8:11], a[24:27], v[52:55], v[8:11]
    v_mfma_f32_16x16x32_bf16 v[12:15], a[28:31], v[52:55], v[12:15]
    s_waitcnt lgkmcnt(0)
    v_add_f32 v16, v16, v32
    v_add_f32 v17, v17, v33
    v_add_f32 v18, v18, v34
    v_add_f32 v19, v19, v35
    v_add_f32 v20, v20, v36
    v_add_f32 v21, v21, v37
    v_add_f32 v22, v22, v38
    v_add_f32 v23, v23, v39
    v_add_f32 v24, v24, v40
    v_add_f32 v25, v25, v41
    v_add_f32 v26, v26, v42
    v_add_f32 v27, v27, v43
    v_add_f32 v28, v28, v44
    v_add_f32 v29, v29, v45
    v_add_f32 v30, v30, v46
    v_add_f32 v31, v31, v47
    ds_write_b128 v127, v[16:19] offset:32768
    ds_write_b128 v127, v[20:23] offset:33792
    ds_write_b128 v127, v[24:27] offset:34816
    ds_write_b128 v127, v[28:31] offset:35840
    s_waitcnt vmcnt(4)
    v_mfma_f32_16x16x32_bf16 v[0:3], a[32:35], v[56:59], v[0:3]
    v_mfma_f32_16x16x32_bf16 v[4:7], a[36:39], v[56:59], v[4:7]
    s_add_u32 s62, s61, 4
    s_and_b32 s62, s62, 3
    s_mul_i32 s62, s62, 56
    s_add_u32 s62, s62, s54
    s_lshl_b32 s62, s62, 10
    s_add_u32 s63, s62, 7168
    s_lshl_b32 s99, s49, 10
    s_add_u32 s99, s99, s62
    buffer_load_dwordx4 v[76:79], v133, s[28:31], s99 offen sc1
    s_add_u32 s99, s99, 1024
    s_cmp_eq_u32 s99, s63
    s_cselect_b32 s99, s62, s99
    v_mfma_f32_16x16x32_bf16 v[8:11], a[40:43], v[56:59], v[8:11]
    v_mfma_f32_16x16x32_bf16 v[12:15], a[44:47], v[56:59], v[12:15]
    buffer_load_dwordx4 v[108:111], v125, s[28:31], s96 offen sc1
    s_waitcnt vmcnt(5)
    v_mfma_f32_16x16x32_bf16 v[0:3], a[48:51], v[60:63], v[0:3]
    v_mfma_f32_16x16x32_bf16 v[4:7], a[52:55], v[60:63], v[4:7]
    buffer_load_dwordx4 v[80:83], v133, s[28:31], s99 offen sc1
    s_add_u32 s99, s99, 1024
    s_cmp_eq_u32 s99, s63
    s_cselect_b32 s99, s62, s99
    v_mfma_f32_16x16x32_bf16 v[8:11], a[56:59], v[60:63], v[8:11]
    v_mfma_f32_16x16x32_bf16 v[12:15], a[60:63], v[60:63], v[12:15]
    s_waitcnt vmcnt(5)
    v_mfma_f32_16x16x32_bf16 v[0:3], a[64:67], v[64:67], v[0:3]
    v_mfma_f32_16x16x32_bf16 v[4:7], a[68:71], v[64:67], v[4:7]
    buffer_load_dwordx4 v[84:87], v133, s[28:31], s99 offen sc1
    s_add_u32 s99, s99, 1024
    s_cmp_eq_u32 s99, s63
    s_cselect_b32 s99, s62, s99
    v_mfma_f32_16x16x32_bf16 v[8:11], a[72:75], v[64:67], v[8:11]
    v_mfma_f32_16x16x32_bf16 v[12:15], a[76:79], v[64:67], v[12:15]
    s_waitcnt lgkmcnt(0)
    s_barrier
    ds_read_b128 v[40:43], v128 offset:34816
    ds_read_b128 v[44:47], v128 offset:35840
    ds_read_b128 v[32:35], v128 offset:32768
    ds_read_b128 v[36:39], v128 offset:33792
    s_waitcnt vmcnt(5)
    v_mfma_f32_16x16x32_bf16 v[0:3], a[80:83], v[68:71], v[0:3]
    v_mfma_f32_16x16x32_bf16 v[4:7], a[84:87], v[68:71], v[4:7]
    buffer_load_dwordx4 v[88:91], v133, s[28:31], s99 offen sc1
    s_add_u32 s99, s99, 1024
    s_cmp_eq_u32 s99, s63
    s_cselect_b32 s99, s62, s99
    v_mfma_f32_16x16x32_bf16 v[8:11], a[88:91], v[68:71], v[8:11]
    v_mfma_f32_16x16x32_bf16 v[12:15], a[92:95], v[68:71], v[12:15]
    s_waitcnt vmcnt(5)
    v_mfma_f32_16x16x32_bf16 v[0:3], a[96:99], v[72:75], v[0:3]
    v_mfma_f32_16x16x32_bf16 v[4:7], a[100:103], v[72:75], v[4:7]
    buffer_load_dwordx4 v[92:95], v133, s[28:31], s99 offen sc1
    s_add_u32 s99, s99, 1024
    s_cmp_eq_u32 s99, s63
    s_cselect_b32 s99, s62, s99
    v_mfma_f32_16x16x32_bf16 v[8:11], a[104:107], v[72:75], v[8:11]
    v_mfma_f32_16x16x32_bf16 v[12:15], a[108:111], v[72:75], v[12:15]
    s_waitcnt vmcnt(5)
    v_mfma_f32_16x16x32_bf16 v[16:19], a[0:3], v[76:79], 0
    v_lshlrev_b32 v48, 16, v138
    v_and_b32 v49, 0xffff0000, v138
    v_mfma_f32_16x16x32_bf16 v[20:23], a[4:7], v[76:79], 0
    buffer_load_dwordx4 v[96:99], v133, s[28:31], s99 offen sc1
    s_add_u32 s99, s99, 1024
    s_cmp_eq_u32 s99, s63
    s_cselect_b32 s99, s62, s99
    v_lshlrev_b32 v50, 16, v139
    v_and_b32 v51, 0xffff0000, v139
    v_mfma_f32_16x16x32_bf16 v[24:27], a[8:11], v[76:79], 0
    v_lshlrev_b32 v52, 16, v140
    v_and_b32 v53, 0xffff0000, v140
    v_mfma_f32_16x16x32_bf16 v[28:31], a[12:15], v[76:79], 0
    v_lshlrev_b32 v54, 16, v141
    v_and_b32 v55, 0xffff0000, v141
    s_waitcnt vmcnt(4)
    v_mfma_f32_16x16x32_bf16 v[16:19], a[16:19], v[80:83], v[16:19]
    v_mfma_f32_16x16x32_bf16 v[20:23], a[20:23], v[80:83], v[20:23]
    buffer_load_dwordx4 v[100:103], v133, s[28:31], s99 offen sc1
    v_mfma_f32_16x16x32_bf16 v[24:27], a[24:27], v[80:83], v[24:27]
    v_mfma_f32_16x16x32_bf16 v[28:31], a[28:31], v[80:83], v[28:31]
    s_waitcnt lgkmcnt(0)
    v_add_f32 v0, v0, v32
    v_add_f32 v1, v1, v33
    v_add_f32 v2, v2, v34
    v_add_f32 v3, v3, v35
    v_add_f32 v4, v4, v36
    v_add_f32 v5, v5, v37
    v_add_f32 v6, v6, v38
    v_add_f32 v7, v7, v39
    v_add_f32 v8, v8, v40
    v_add_f32 v9, v9, v41
    v_add_f32 v10, v10, v42
    v_add_f32 v11, v11, v43
    v_add_f32 v12, v12, v44
    v_add_f32 v13, v13, v45
    v_add_f32 v14, v14, v46
    v_add_f32 v15, v15, v47
    ds_write_b128 v127, v[0:3] offset:0
    ds_write_b128 v127, v[4:7] offset:1024
    ds_write_b128 v127, v[8:11] offset:2048
    ds_write_b128 v127, v[12:15] offset:3072
    s_waitcnt vmcnt(4)
    v_mfma_f32_16x16x32_bf16 v[16:19], a[32:35], v[84:87], v[16:19]
    v_lshlrev_b32 v56, 16, v104
    v_and_b32 v57, 0xffff0000, v104
    v_mfma_f32_16x16x32_bf16 v[20:23], a[36:39], v[84:87], v[20:23]
    v_lshlrev_b32 v58, 16, v105
    v_and_b32 v59, 0xffff0000, v105
    v_mfma_f32_16x16x32_bf16 v[24:27], a[40:43], v[84:87], v[24:27]
    v_lshlrev_b32 v60, 16, v106
    v_and_b32 v61, 0xffff0000, v106
    v_mfma_f32_16x16x32_bf16 v[28:31], a[44:47], v[84:87], v[28:31]
    v_lshlrev_b32 v62, 16, v107
    v_and_b32 v63, 0xffff0000, v107
    s_waitcnt vmcnt(3)
    v_mfma_f32_16x16x32_bf16 v[16:19], a[48:51], v[88:91], v[16:19]
    v_sub_f32 v64, v48, v134
    v_sub_f32 v65, v49, v134
    v_mfma_f32_16x16x32_bf16 v[20:23], a[52:55], v[88:91], v[20:23]
    v_sub_f32 v66, v50, v134
    v_sub_f32 v67, v51, v134
    v_mfma_f32_16x16x32_bf16 v[24:27], a[56:59], v[88:91], v[24:27]
    v_sub_f32 v68, v52, v134
    v_sub_f32 v69, v53, v134
    v_mfma_f32_16x16x32_bf16 v[28:31], a[60:63], v[88:91], v[28:31]
    v_sub_f32 v70, v54, v134
    v_sub_f32 v71, v55, v134
    s_waitcnt vmcnt(2)
    v_mfma_f32_16x16x32_bf16 v[16:19], a[64:67], v[92:95], v[16:19]
    v_mul_f32 v64, v64, v136
    v_mul_f32 v65, v65, v136
    v_mfma_f32_16x16x32_bf16 v[20:23], a[68:71], v[92:95], v[20:23]
    v_mul_f32 v66, v66, v136
    v_mul_f32 v67, v67, v136
    v_mfma_f32_16x16x32_bf16 v[24:27], a[72:75], v[92:95], v[24:27]
    v_mul_f32 v68, v68, v136
    v_mul_f32 v69, v69, v136
    v_mfma_f32_16x16x32_bf16 v[28:31], a[76:79], v[92:95], v[28:31]
    v_mul_f32 v70, v70, v136
    v_mul_f32 v71, v71, v136
    s_waitcnt vmcnt(6)
    s_mov_b32 s97, 0
L_chk_z:
    v_max3_u32 v115, v108, v109, v110
    v_max_u32 v115, v115, v111
    v_cmp_eq_u32 vcc, -1, v115
    s_add_u32 s97, s97, 1
    s_nop 3
    s_cbranch_vccz L_ok_z
    s_cmp_gt_u32 s97, 20000
    s_cbranch_scc1 L_ok_z
    s_sleep 2
    buffer_load_dwordx4 v[108:111], v125, s[28:31], s96 offen sc1
    s_waitcnt vmcnt(0)
    s_branch L_chk_z
L_ok_z:
    ds_write_b128 v116, v[108:111]
    s_waitcnt lgkmcnt(0)
    s_barrier
    ds_read_b64_tr_b16 v[120:121], v132
    ds_read_b64_tr_b16 v[122:123], v132 offset:512
    ds_read_b128 v[40:43], v128 offset:2048
    ds_read_b128 v[44:47], v128 offset:3072
    ds_read_b128 v[32:35], v128 offset:0
    ds_read_b128 v[36:39], v128 offset:1024
    s_waitcnt vmcnt(1)
    v_mfma_f32_16x16x32_bf16 v[16:19], a[80:83], v[96:99], v[16:19]
    v_mfma_f32_16x16x32_bf16 v[20:23], a[84:87], v[96:99], v[20:23]
    v_mfma_f32_16x16x32_bf16 v[24:27], a[88:91], v[96:99], v[24:27]
    v_mfma_f32_16x16x32_bf16 v[28:31], a[92:95], v[96:99], v[28:31]
    s_waitcnt lgkmcnt(4)
    s_waitcnt vmcnt(0)
    v_mfma_f32_16x16x32_bf16 v[16:19], a[96:99], v[100:103], v[16:19]
    v_lshlrev_b32 v72, 16, v120
    v_and_b32 v73, 0xffff0000, v120
    v_mfma_f32_16x16x32_bf16 v[20:23], a[100:103], v[100:103], v[20:23]
    v_lshlrev_b32 v74, 16, v121
    v_and_b32 v75, 0xffff0000, v121
    v_mfma_f32_16x16x32_bf16 v[24:27], a[104:107], v[100:103], v[24:27]
    v_lshlrev_b32 v76, 16, v122
    v_and_b32 v77, 0xffff0000, v122
    v_mfma_f32_16x16x32_bf16 v[28:31], a[108:111], v[100:103], v[28:31]
    v_lshlrev_b32 v78, 16, v123
    v_and_b32 v79, 0xffff0000, v123
    v_xor_b32 v116, 16384, v127
    v_pk_mul_f32 v[64:65], v[64:65], v[72:73]
    v_pk_mul_f32 v[66:67], v[66:67], v[74:75]
    v_pk_mul_f32 v[68:69], v[68:69], v[76:77]
    v_pk_mul_f32 v[70:71], v[70:71], v[78:79]
    s_waitcnt lgkmcnt(0)
    v_pk_add_f32 v[24:25], v[24:25], v[40:41]
    v_pk_add_f32 v[26:27], v[26:27], v[42:43]
    v_pk_add_f32 v[28:29], v[28:29], v[44:45]
    v_pk_add_f32 v[30:31], v[30:31], v[46:47]
    ds_write_b128 v127, v[24:27] offset:32768
    ds_write_b128 v127, v[28:31] offset:33792
    v_pk_add_f32 v[16:17], v[16:17], v[32:33]
    v_pk_add_f32 v[18:19], v[18:19], v[34:35]
    v_pk_add_f32 v[20:21], v[20:21], v[36:37]
    v_pk_add_f32 v[22:23], v[22:23], v[38:39]
    v_pk_fma_f32 v[16:17], v[16:17], v[136:137], v[56:57] op_sel:[0,1,0] op_sel_hi:[1,1,1]
    v_pk_fma_f32 v[18:19], v[18:19], v[136:137], v[58:59] op_sel:[0,1,0] op_sel_hi:[1,1,1]
    v_pk_fma_f32 v[20:21], v[20:21], v[136:137], v[60:61] op_sel:[0,1,0] op_sel_hi:[1,1,1]
    v_pk_fma_f32 v[22:23], v[22:23], v[136:137], v[62:63] op_sel:[0,1,0] op_sel_hi:[1,1,1]
    s_waitcnt lgkmcnt(0)
    s_barrier
    ds_read_b128 v[32:35], v116 offset:32768
    ds_read_b128 v[36:39], v116 offset:33792
    s_waitcnt lgkmcnt(1)
    v_pk_fma_f32 v[16:17], v[32:33], v[136:137], v[16:17] op_sel:[0,1,0] op_sel_hi:[1,1,1]
    v_pk_fma_f32 v[18:19], v[34:35], v[136:137], v[18:19] op_sel:[0,1,0] op_sel_hi:[1,1,1]
    v_mul_f32 v0, 0xbfb8aa3b, v16
    v_mul_f32 v1, 0xbfb8aa3b, v17
    v_mul_f32 v2, 0xbfb8aa3b, v18
    v_mul_f32 v3, 0xbfb8aa3b, v19
    v_exp_f32 v0, v0
    v_exp_f32 v1, v1
    v_exp_f32 v2, v2
    v_exp_f32 v3, v3
    s_waitcnt lgkmcnt(0)
    v_pk_fma_f32 v[20:21], v[36:37], v[136:137], v[20:21] op_sel:[0,1,0] op_sel_hi:[1,1,1]
    v_pk_fma_f32 v[22:23], v[38:39], v[136:137], v[22:23] op_sel:[0,1,0] op_sel_hi:[1,1,1]
    v_mul_f32 v4, 0xbfb8aa3b, v20
    v_mul_f32 v5, 0xbfb8aa3b, v21
    v_mul_f32 v6, 0xbfb8aa3b, v22
    v_mul_f32 v7, 0xbfb8aa3b, v23
    v_exp_f32 v4, v4
    v_exp_f32 v5, v5
    v_exp_f32 v6, v6
    v_exp_f32 v7, v7
    v_pk_mul_f32 v[64:65], v[64:65], v[16:17]
    v_pk_mul_f32 v[66:67], v[66:67], v[18:19]
    v_pk_mul_f32 v[68:69], v[68:69], v[20:21]
    v_pk_mul_f32 v[70:71], v[70:71], v[22:23]
    v_add_f32 v0, 1.0, v0
    v_add_f32 v1, 1.0, v1
    v_add_f32 v2, 1.0, v2
    v_add_f32 v3, 1.0, v3
    v_add_f32 v4, 1.0, v4
    v_add_f32 v5, 1.0, v5
    v_add_f32 v6, 1.0, v6
    v_add_f32 v7, 1.0, v7
    v_rcp_f32 v0, v0
    v_rcp_f32 v1, v1
    v_rcp_f32 v2, v2
    v_rcp_f32 v3, v3
    v_rcp_f32 v4, v4
    v_rcp_f32 v5, v5
    v_rcp_f32 v6, v6
    v_rcp_f32 v7, v7
    v_pk_fma_f32 v[64:65], v[64:65], v[0:1], v[48:49]
    v_pk_fma_f32 v[66:67], v[66:67], v[2:3], v[50:51]
    v_pk_fma_f32 v[68:69], v[68:69], v[4:5], v[52:53]
    v_pk_fma_f32 v[70:71], v[70:71], v[6:7], v[54:55]
    v_cvt_pk_bf16_f32 v8, v64, v65
    v_cvt_pk_bf16_f32 v9, v66, v67
    v_cvt_pk_bf16_f32 v10, v68, v69
    v_cvt_pk_bf16_f32 v11, v70, v71
    buffer_store_dwordx4 v[8:11], v119, s[32:35], 0 offen
    s_endpgm
L_service:
    s_and_b32 s36, s2, 7
    s_lshr_b32 s37, s2, 3
    s_lshl_b32 s39, s36, 2
    s_add_u32 s39, s39, s37
    s_lshr_b32 s92, s36, 1
    s_lshl_b32 s92, s92, 2
    s_add_u32 s92, s92, s37
    s_and_b32 s93, s36, 1
    s_mul_i32 s93, s93, 14
    s_add_u32 s42, s92, s93
    s_cmp_ge_u32 s92, 14
    s_cselect_b32 s42, 28, s42
    s_lshl_b32 s92, s39, 6
    s_lshl_b32 s93, s43, 3
    s_add_u32 s92, s92, s93
    s_mul_i32 s92, s92, 896
    v_lshl_add_u32 v1, v81, 4, v84
    v_add_u32 v1, s92, v1
    v_lshrrev_b32 v0, 7, v113
    v_and_b32 v2, 0x70, v113
    v_mul_u32_u24 v0, 3584, v0
    v_add_u32 v0, v0, v2
    v_mov_b32 v4, 0
    v_mov_b32 v5, 0
    v_mov_b32 v6, 0
    v_mov_b32 v7, 0
    s_waitcnt lgkmcnt(0)
    s_mov_b32 s28, s90
    s_and_b32 s29, s91, 0xffff
    s_mov_b32 s30, 16777216
    s_mov_b32 s31, 0x00020000
    s_mov_b32 s4, s64
    s_and_b32 s5, s65, 0xffff
    s_mov_b32 s6, 1835008
    s_mov_b32 s7, 0x00020000
    s_mov_b32 s20, s78
    s_and_b32 s21, s79, 0xffff
    s_mov_b32 s22, 1605632
    s_mov_b32 s23, 0x00020000
    s_or_b32 s92, s2, s43
    s_cmp_lg_u32 s92, 0
    s_cbranch_scc1 L_svc_nn
    s_memrealtime s[94:95]
    s_waitcnt lgkmcnt(0)
    s_or_b32 s94, s94, 1
    v_mov_b32 v2, s94
    v_mov_b32 v3, s95
    s_mov_b64 exec, 1
    global_store_dwordx2 v4, v[2:3], s[88:89] sc1
    s_mov_b64 exec, -1
L_svc_nn:
    s_min_u32 s93, s42, 27
    s_lshl_b32 s93, s93, 7
    buffer_load_dwordx4 v[36:39], v0, s[20:23], s93 offen
    s_add_u32 s93, s93, 229376
    buffer_load_dwordx4 v[40:43], v0, s[20:23], s93 offen
    s_add_u32 s93, s93, 229376
    buffer_load_dwordx4 v[44:47], v0, s[20:23], s93 offen
    s_add_u32 s93, s93, 229376
    buffer_load_dwordx4 v[48:51], v0, s[20:23], s93 offen
    s_add_u32 s93, s93, 229376
    buffer_load_dwordx4 v[52:55], v0, s[20:23], s93 offen
    s_add_u32 s93, s93, 229376
    buffer_load_dwordx4 v[56:59], v0, s[20:23], s93 offen
    s_add_u32 s93, s93, 229376
    buffer_load_dwordx4 v[60:63], v0, s[20:23], s93 offen
    buffer_load_dwordx4 v[8:11], v1, s[4:7], 0 offen offset:0
    buffer_load_dwordx4 v[12:15], v1, s[4:7], 0 offen offset:128
    buffer_load_dwordx4 v[16:19], v1, s[4:7], 0 offen offset:256
    buffer_load_dwordx4 v[20:23], v1, s[4:7], 0 offen offset:384
    buffer_load_dwordx4 v[24:27], v1, s[4:7], 0 offen offset:512
    buffer_load_dwordx4 v[28:31], v1, s[4:7], 0 offen offset:640
    buffer_load_dwordx4 v[32:35], v1, s[4:7], 0 offen offset:768
    v_mov_b32 v117, 0
    v_mov_b32 v68, 0x00003f80
    v_mov_b32 v69, 0x3f800000
    v_mov_b32 v72, 0x3f803f80
    v_mov_b32 v73, 1.0
    v_mov_b32 v88, 0
    v_mov_b32 v89, 0
    v_mov_b32 v90, 0
    v_mov_b32 v91, 0
    v_mov_b32 v92, 0
    v_mov_b32 v93, 0
    v_mov_b32 v94, 0
    v_mov_b32 v95, 0
    s_waitcnt vmcnt(13)
    v_dot2_f32_bf16 v88, v36, v68, v88
    v_dot2_f32_bf16 v89, v36, v69, v89
    v_dot2_f32_bf16 v90, v37, v68, v90
    v_dot2_f32_bf16 v91, v37, v69, v91
    v_dot2_f32_bf16 v92, v38, v68, v92
    v_dot2_f32_bf16 v93, v38, v69, v93
    v_dot2_f32_bf16 v94, v39, v68, v94
    v_dot2_f32_bf16 v95, v39, v69, v95
    s_waitcnt vmcnt(12)
    v_dot2_f32_bf16 v88, v40, v68, v88
    v_dot2_f32_bf16 v89, v40, v69, v89
    v_dot2_f32_bf16 v90, v41, v68, v90
    v_dot2_f32_bf16 v91, v41, v69, v91
    v_dot2_f32_bf16 v92, v42, v68, v92
    v_dot2_f32_bf16 v93, v42, v69, v93
    v_dot2_f32_bf16 v94, v43, v68, v94
    v_dot2_f32_bf16 v95, v43, v69, v95
    s_waitcnt vmcnt(11)
    v_dot2_f32_bf16 v88, v44, v68, v88
    v_dot2_f32_bf16 v89, v44, v69, v89
    v_dot2_f32_bf16 v90, v45, v68, v90
    v_dot2_f32_bf16 v91, v45, v69, v91
    v_dot2_f32_bf16 v92, v46, v68, v92
    v_dot2_f32_bf16 v93, v46, v69, v93
    v_dot2_f32_bf16 v94, v47, v68, v94
    v_dot2_f32_bf16 v95, v47, v69, v95
    s_waitcnt vmcnt(10)
    v_dot2_f32_bf16 v88, v48, v68, v88
    v_dot2_f32_bf16 v89, v48, v69, v89
    v_dot2_f32_bf16 v90, v49, v68, v90
    v_dot2_f32_bf16 v91, v49, v69, v91
    v_dot2_f32_bf16 v92, v50, v68, v92
    v_dot2_f32_bf16 v93, v50, v69, v93
    v_dot2_f32_bf16 v94, v51, v68, v94
    v_dot2_f32_bf16 v95, v51, v69, v95
    s_waitcnt vmcnt(9)
    v_dot2_f32_bf16 v88, v52, v68, v88
    v_dot2_f32_bf16 v89, v52, v69, v89
    v_dot2_f32_bf16 v90, v53, v68, v90
    v_dot2_f32_bf16 v91, v53, v69, v91
    v_dot2_f32_bf16 v92, v54, v68, v92
    v_dot2_f32_bf16 v93, v54, v69, v93
    v_dot2_f32_bf16 v94, v55, v68, v94
    v_dot2_f32_bf16 v95, v55, v69, v95
    s_waitcnt vmcnt(8)
    v_dot2_f32_bf16 v88, v56, v68, v88
    v_dot2_f32_bf16 v89, v56, v69, v89
    v_dot2_f32_bf16 v90, v57, v68, v90
    v_dot2_f32_bf16 v91, v57, v69, v91
    v_dot2_f32_bf16 v92, v58, v68, v92
    v_dot2_f32_bf16 v93, v58, v69, v93
    v_dot2_f32_bf16 v94, v59, v68, v94
    v_dot2_f32_bf16 v95, v59, v69, v95
    s_waitcnt vmcnt(7)
    v_dot2_f32_bf16 v88, v60, v68, v88
    v_dot2_f32_bf16 v89, v60, v69, v89
    v_dot2_f32_bf16 v90, v61, v68, v90
    v_dot2_f32_bf16 v91, v61, v69, v91
    v_dot2_f32_bf16 v92, v62, v68, v92
    v_dot2_f32_bf16 v93, v62, v69, v93
    v_dot2_f32_bf16 v94, v63, v68, v94
    v_dot2_f32_bf16 v95, v63, v69, v95
    global_load_dwordx2 v[66:67], v117, s[88:89] sc1
    v_add_f32_dpp v88, v88, v88 row_ror:8 row_mask:0xf bank_mask:0xf
    v_add_f32_dpp v89, v89, v89 row_ror:8 row_mask:0xf bank_mask:0xf
    v_add_f32_dpp v90, v90, v90 row_ror:8 row_mask:0xf bank_mask:0xf
    v_add_f32_dpp v91, v91, v91 row_ror:8 row_mask:0xf bank_mask:0xf
    v_add_f32_dpp v92, v92, v92 row_ror:8 row_mask:0xf bank_mask:0xf
    v_add_f32_dpp v93, v93, v93 row_ror:8 row_mask:0xf bank_mask:0xf
    v_add_f32_dpp v94, v94, v94 row_ror:8 row_mask:0xf bank_mask:0xf
    v_add_f32_dpp v95, v95, v95 row_ror:8 row_mask:0xf bank_mask:0xf
    v_mfma_f32_16x16x4_f32 v[36:39], v73, v88, 0
    v_mfma_f32_16x16x4_f32 v[40:43], v73, v89, 0
    v_mfma_f32_16x16x4_f32 v[44:47], v73, v90, 0
    v_mfma_f32_16x16x4_f32 v[48:51], v73, v91, 0
    v_mfma_f32_16x16x4_f32 v[52:55], v73, v92, 0
    v_mfma_f32_16x16x4_f32 v[56:59], v73, v93, 0
    v_mfma_f32_16x16x4_f32 v[60:63], v73, v94, 0
    v_mfma_f32_16x16x4_f32 v[76:79], v73, v95, 0
    s_lshl_b32 s92, s43, 8
    v_lshlrev_b32 v2, 5, v81
    v_add_u32 v2, s92, v2
    s_mov_b64 exec, 0xff
    ds_write_b32 v2, v36 offset:0
    ds_write_b32 v2, v40 offset:4
    ds_write_b32 v2, v44 offset:8
    ds_write_b32 v2, v48 offset:12
    ds_write_b32 v2, v52 offset:16
    ds_write_b32 v2, v56 offset:20
    ds_write_b32 v2, v60 offset:24
    ds_write_b32 v2, v76 offset:28
    s_mov_b64 exec, -1
    s_waitcnt lgkmcnt(0) vmcnt(0)
    s_barrier
    s_mov_b32 s97, 0
L_chk_snon:
    v_cmp_eq_u32 vcc, 0, v66
    s_add_u32 s97, s97, 1
    s_nop 3
    s_cbranch_vccz L_ok_snon
    s_cmp_gt_u32 s97, 20000
    s_cbranch_scc1 L_ok_snon
    s_sleep 8
    global_load_dwordx2 v[66:67], v117, s[88:89] sc1
    s_waitcnt vmcnt(0)
    s_branch L_chk_snon
L_ok_snon:
    s_cmp_ge_u32 s42, 28
    s_cbranch_scc1 L_svc_st
    s_cmp_lg_u32 s43, 0
    s_cbranch_scc1 L_svc_st
    v_lshlrev_b32 v3, 3, v112
    v_and_b32 v3, 0xff, v3
    ds_read_b64 v[36:37], v3 offset:0
    ds_read_b64 v[38:39], v3 offset:256
    ds_read_b64 v[40:41], v3 offset:512
    ds_read_b64 v[42:43], v3 offset:768
    ds_read_b64 v[44:45], v3 offset:1024
    ds_read_b64 v[46:47], v3 offset:1280
    ds_read_b64 v[48:49], v3 offset:1536
    ds_read_b64 v[50:51], v3 offset:1792
    s_waitcnt lgkmcnt(0)
    v_pk_add_f32 v[36:37], v[36:37], v[38:39]
    v_pk_add_f32 v[36:37], v[36:37], v[40:41]
    v_pk_add_f32 v[36:37], v[36:37], v[42:43]
    v_pk_add_f32 v[36:37], v[36:37], v[44:45]
    v_pk_add_f32 v[36:37], v[36:37], v[46:47]
    v_pk_add_f32 v[36:37], v[36:37], v[48:49]
    v_pk_add_f32 v[36:37], v[36:37], v[50:51]
    v_mov_b32 v64, v36
    v_mov_b32 v65, v37
    s_lshl_b32 s92, s42, 9
    s_add_u32 s92, s92, 11042816
    s_mov_b32 exec_hi, 0
    buffer_store_dwordx4 v[64:67], v133, s[28:31], s92 offen sc1
    s_mov_b64 exec, -1
L_svc_st:
    v_dot2_f32_bf16 v4, v8, v72, v4
    v_dot2_f32_bf16 v6, v8, v8, v6
    v_dot2_f32_bf16 v5, v9, v72, v5
    v_dot2_f32_bf16 v7, v9, v9, v7
    v_dot2_f32_bf16 v4, v10, v72, v4
    v_dot2_f32_bf16 v6, v10, v10, v6
    v_dot2_f32_bf16 v5, v11, v72, v5
    v_dot2_f32_bf16 v7, v11, v11, v7
    v_dot2_f32_bf16 v4, v12, v72, v4
    v_dot2_f32_bf16 v6, v12, v12, v6
    v_dot2_f32_bf16 v5, v13, v72, v5
    v_dot2_f32_bf16 v7, v13, v13, v7
    v_dot2_f32_bf16 v4, v14, v72, v4
    v_dot2_f32_bf16 v6, v14, v14, v6
    v_dot2_f32_bf16 v5, v15, v72, v5
    v_dot2_f32_bf16 v7, v15, v15, v7
    v_dot2_f32_bf16 v4, v16, v72, v4
    v_dot2_f32_bf16 v6, v16, v16, v6
    v_dot2_f32_bf16 v5, v17, v72, v5
    v_dot2_f32_bf16 v7, v17, v17, v7
    v_dot2_f32_bf16 v4, v18, v72, v4
    v_dot2_f32_bf16 v6, v18, v18, v6
    v_dot2_f32_bf16 v5, v19, v72, v5
    v_dot2_f32_bf16 v7, v19, v19, v7
    v_dot2_f32_bf16 v4, v20, v72, v4
    v_dot2_f32_bf16 v6, v20, v20, v6
    v_dot2_f32_bf16 v5, v21, v72, v5
    v_dot2_f32_bf16 v7, v21, v21, v7
    v_dot2_f32_bf16 v4, v22, v72, v4
    v_dot2_f32_bf16 v6, v22, v22, v6
    v_dot2_f32_bf16 v5, v23, v72, v5
    v_dot2_f32_bf16 v7, v23, v23, v7
    v_dot2_f32_bf16 v4, v24, v72, v4
    v_dot2_f32_bf16 v6, v24, v24, v6
    v_dot2_f32_bf16 v5, v25, v72, v5
    v_dot2_f32_bf16 v7, v25, v25, v7
    v_dot2_f32_bf16 v4, v26, v72, v4
    v_dot2_f32_bf16 v6, v26, v26, v6
    v_dot2_f32_bf16 v5, v27, v72, v5
    v_dot2_f32_bf16 v7, v27, v27, v7
    v_dot2_f32_bf16 v4, v28, v72, v4
    v_dot2_f32_bf16 v6, v28, v28, v6
    v_dot2_f32_bf16 v5, v29, v72, v5
    v_dot2_f32_bf16 v7, v29, v29, v7
    v_dot2_f32_bf16 v4, v30, v72, v4
    v_dot2_f32_bf16 v6, v30, v30, v6
    v_dot2_f32_bf16 v5, v31, v72, v5
    v_dot2_f32_bf16 v7, v31, v31, v7
    v_dot2_f32_bf16 v4, v32, v72, v4
    v_dot2_f32_bf16 v6, v32, v32, v6
    v_dot2_f32_bf16 v5, v33, v72, v5
    v_dot2_f32_bf16 v7, v33, v33, v7
    v_dot2_f32_bf16 v4, v34, v72, v4
    v_dot2_f32_bf16 v6, v34, v34, v6
    v_dot2_f32_bf16 v5, v35, v72, v5
    v_dot2_f32_bf16 v7, v35, v35, v7
    s_nop 1
    v_add_f32 v4, v4, v5
    v_add_f32 v6, v6, v7
    s_nop 0
    v_add_f32_dpp v4, v4, v4 quad_perm:[1,0,3,2] row_mask:0xf bank_mask:0xf
    v_add_f32_dpp v6, v6, v6 quad_perm:[1,0,3,2] row_mask:0xf bank_mask:0xf
    s_nop 0
    v_add_f32_dpp v4, v4, v4 quad_perm:[2,3,0,1] row_mask:0xf bank_mask:0xf
    v_add_f32_dpp v6, v6, v6 quad_perm:[2,3,0,1] row_mask:0xf bank_mask:0xf
    s_nop 0
    v_add_f32_dpp v4, v4, v4 row_half_mirror row_mask:0xf bank_mask:0xf
    v_add_f32_dpp v6, v6, v6 row_half_mirror row_mask:0xf bank_mask:0xf
    v_mul_f32 v4, 0x3b124925, v4
    v_mul_f32 v6, 0x3b124925, v6
    v_fma_f32 v6, -v4, v4, v6
    v_max_f32 v6, 0, v6
    v_cvt_pk_bf16_f32 v5, v4, v6
    v_lshlrev_b32 v64, 16, v5
    v_and_b32 v6, 0xffff0000, v5
    v_add_f32 v6, 0x3727c5ac, v6
    v_cvt_pk_bf16_f32 v5, v6, v6
    v_and_b32 v6, 0xffff0000, v5
    v_sqrt_f32 v6, v6
    s_nop 0
    v_cvt_pk_bf16_f32 v5, v6, v6
    v_and_b32 v65, 0xffff0000, v5
    s_lshl_b32 s92, s39, 10
    s_lshl_b32 s93, s43, 7
    s_add_u32 s92, s92, s93
    s_add_u32 s92, s92, 11010048
    v_lshlrev_b32 v2, 4, v80
    v_cmp_eq_u32 vcc, 0, v81
    s_nop 0
    s_and_saveexec_b64 s[62:63], vcc
    buffer_store_dwordx4 v[64:67], v2, s[28:31], s92 offen sc1
    s_mov_b64 exec, -1
    s_mov_b32 s24, s82
    s_and_b32 s25, s83, 0xffff
    s_mov_b32 s26, 1605632
    s_mov_b32 s27, 0x00020000
    s_mul_i32 s92, s2, 50176
    v_lshlrev_b32 v96, 3, v113
    v_min_u32 v96, 50048, v96
    buffer_load_dword v71, v96, s[24:27], s92 offen
    s_getpc_b64 s[94:95]
L_pc:
    s_sub_u32 s94, s94, L_pc-recurrent_scan__ssm_conv_h3__dense_activation_squared_relu__prompt_kernel
    s_subb_u32 s95, s95, 0
    v_lshlrev_b32 v3, 2, v113
    v_min_u32 v3, L_pc-recurrent_scan__ssm_conv_h3__dense_activation_squared_relu__prompt_kernel, v3
    global_load_dword v70, v3, s[94:95]
L_end:
    s_endpgm
.section .rodata,"a"
.p2align 6
.amdhsa_kernel recurrent_scan__ssm_conv_h3__dense_activation_squared_relu__prompt_kernel
  .amdhsa_next_free_vgpr 256
  .amdhsa_next_free_sgpr 102
  .amdhsa_accum_offset 144
  .amdhsa_group_segment_fixed_size 0
  .amdhsa_kernarg_size 112
  .amdhsa_user_sgpr_count 2
  .amdhsa_user_sgpr_kernarg_segment_ptr 1
  .amdhsa_system_sgpr_workgroup_id_x 1
.end_amdhsa_kernel
```
